```python
import torch

def _softmax(x, axis=-1):
    return torch.softmax(x, dim=axis)

def _gelu(x):
    return torch.nn.functional.gelu(x, approximate='tanh')

def _silu(x):
    return torch.nn.functional.silu(x)

def _sigmoid(x):
    return torch.sigmoid(x)

def _layernorm(x, axis=-1, eps=1e-05):
    m = x.mean(dim=axis, keepdim=True)
    v = x.var(dim=axis, keepdim=True, unbiased=False)
    return (x - m) / torch.sqrt(v + eps)

def _scatter_add(tgt, idx, src, axis=0):
    return tgt.clone().index_add_(axis, idx, src)

def _segment_sum(src, seg, n):
    out = torch.zeros((n,) + src.shape[1:], dtype=src.dtype)
    return out.index_add_(0, seg, src)

def _pad(x, pw):
    flat = tuple((v for pair in reversed(pw) for v in pair))
    return torch.nn.functional.pad(x, flat)
kernel_name = 'parallel_sum__grouped_kv_mqa__mixer_gmlp__prompt'

def setup_inputs():

    _w = lambda a: (lambda t: t.to(torch.bfloat16) if t.is_floating_point() else t)(torch.as_tensor(a))

    def _A_setup():
        B, S, D, H = (1, 2048, 640, 32)
        Dh = D // H
        return {'x': _w((lambda *s: torch.randn(*s, dtype=torch.bfloat16) * 0.05)(B, S, D)), 'wq': _w((lambda *s: torch.randn(*s, dtype=torch.bfloat16) * 0.2)(D, H * Dh)), 'wk': _w((lambda *s: torch.randn(*s, dtype=torch.bfloat16) * 0.2)(D, Dh)), 'wv': _w((lambda *s: torch.randn(*s, dtype=torch.bfloat16) * 0.1)(D, Dh)), 'wo': _w((lambda *s: torch.randn(*s, dtype=torch.bfloat16) * 0.1)(H * Dh, D))}
    _A_in = _A_setup()

    def _B_setup():
        B, S, D, F = (1, 2048, 640, 1728)
        Fh = F // 2
        return {'x': _w((lambda *s: torch.randn(*s, dtype=torch.bfloat16) * 0.05)(B, S, D)), 'w_in': _w((lambda *s: torch.randn(*s, dtype=torch.bfloat16) * 0.8)(D, 2 * Fh)), 'w_sp': _w(0.01 * (lambda *s: torch.randn(*s, dtype=torch.bfloat16) * 0.8)(S, S)), 'b_sp': _w(1.0 + 0.01 * (lambda *s: torch.randn(*s, dtype=torch.bfloat16) * 0.1)(S)), 'w_out': _w((lambda *s: torch.randn(*s, dtype=torch.bfloat16) * 0.1)(Fh, D))}
    _B_in = _B_setup()
    return {'A_x': _A_in['x'], 'A_wq': _A_in['wq'], 'A_wk': _A_in['wk'], 'A_wv': _A_in['wv'], 'A_wo': _A_in['wo'], 'B_x': _B_in['x'], 'B_w_in': _B_in['w_in'], 'B_w_sp': _B_in['w_sp'], 'B_b_sp': _B_in['b_sp'], 'B_w_out': _B_in['w_out']}

def reference(A_x, A_wq, A_wk, A_wv, A_wo, B_x, B_w_in, B_w_sp, B_b_sp, B_w_out):

    def _A_ref(x, wq, wk, wv, wo):
        B, S, D = x.shape
        H = 32
        Dh = D // H
        q = (lambda x, *d: x.permute(*d))((x @ wq).reshape(B, S, H, Dh), 0, 2, 1, 3)
        k = x @ wk
        v = x @ wv
        scores = torch.einsum('bhqd,bkd->bhqk', q, k) * Dh ** (-0.5)
        p = _softmax(scores, axis=-1)
        o = torch.einsum('bhqk,bkd->bhqd', p, v)
        return (lambda x, *d: x.permute(*d))(o, 0, 2, 1, 3).reshape(B, S, H * Dh) @ wo

    def _B_ref(x, w_in, w_sp, b_sp, w_out):
        B, S, D = x.shape
        F = w_in.shape[-1]
        Fh = F // 2
        z = _gelu(torch.einsum('bsd,df->bsf', x, w_in))
        z1 = z[..., :Fh].clone()
        z2 = _layernorm(z[..., Fh:], axis=-1)
        g = torch.einsum('ts,bsf->btf', w_sp, z2) + b_sp[None, :, None]
        return torch.einsum('bsf,fd->bsd', z1 * g, w_out)
    x = A_x
    xn = _layernorm(x, axis=-1)
    return x + _A_ref(xn, A_wq, A_wk, A_wv, A_wo) + _B_ref(xn, B_w_in, B_w_sp, B_b_sp, B_w_out)
```

```asm
; @launch grid=(256,1,1) block=(768,1,1) lds=163840
.amdgcn_target "amdgcn-amd-amdhsa--gfx950"
.text
.globl parallel_sum__grouped_kv_mqa__mixer_gmlp__prompt_kernel
.p2align 8
.type parallel_sum__grouped_kv_mqa__mixer_gmlp__prompt_kernel,@function
parallel_sum__grouped_kv_mqa__mixer_gmlp__prompt_kernel:
  s_cmp_ge_u32 s2, 256
  s_cbranch_scc1 LF_end
  s_load_dwordx8 s[4:11], s[0:1], 0
  s_load_dwordx2 s[12:13], s[0:1], 48
  s_load_dwordx4 s[16:19], s[0:1], 88
  v_and_b32 v1, 63, v0
  v_lshrrev_b32 v16, 6, v0
  s_and_b32 s44, s2, 7
  v_readfirstlane_b32 s40, v16
  s_lshr_b32 s45, s2, 3
  s_lshr_b32 s41, s44, 1
  s_lshr_b32 s50, s45, 3
  s_lshl2_add_u32 s41, s41, s50
  s_and_b32 s42, s44, 1
  s_and_b32 s50, s45, 7
  s_lshl3_add_u32 s42, s42, s50
  s_and_b32 s43, s40, 3
  v_lshlrev_b32 v2, 4, v1
  v_lshlrev_b32 v3, 3, v1
  s_cmp_lt_u32 s40, 8
  s_cbranch_scc1 LF_A
  s_setprio 3
  s_lshl_b32 s48, s43, 8
  s_add_u32 s48, s48, 160768
  v_lshl_add_u32 v7, v1, 2, s48
  v_mov_b32 v20, 0
  ds_write_b32 v7, v20
  v_lshlrev_b32 v22, 2, v1
  v_add_u32 v22, 160256, v22
  ds_write_b32 v22, v20
  v_add_u32 v22, -4608, v22
  ds_write_b32 v22, v20
  ds_write_b32 v22, v20 offset:256
  v_mov_b32 v14, 0
  s_memrealtime s[54:55]
  s_lshl_b32 s48, s41, 7
  s_lshl3_add_u32 s48, s42, s48
  s_lshl1_add_u32 s48, s43, s48
  v_lshrrev_b32 v32, 5, v1
  v_add_u32 v32, s48, v32
  v_mul_u32_u24 v32, 1280, v32
  v_and_b32 v33, 0xf8, v3
  v_add_u32 v33, v33, v32
  v_and_b32 v34, 0x1f0, v2
  v_add_u32 v32, v34, v32
  v_lshrrev_b32 v22, 3, v1
  v_mul_u32_u24 v22, 1280, v22
  v_lshrrev_b32 v23, 4, v1
  v_xor_b32 v23, v23, v1
  v_and_b32 v23, 7, v23
  v_lshl_add_u32 v8, v23, 4, v22
  v_xor_b32 v23, 4, v23
  v_lshl_add_u32 v9, v23, 4, v22
  v_add_u32 v9, 10240, v9
  v_lshrrev_b32 v24, 2, v1
  s_lshl_b32 s48, s43, 4
  v_add_u32 v24, s48, v24
  v_and_b32 v25, 0x30, v2
  s_lshl_b32 s63, s43, 12
  s_lshl_b32 s14, s43, 10
  s_add_u32 s14, s14, 16384
  s_lshl2_add_u32 s47, s41, s43
  s_mul_i32 s56, s47, 40960
  s_mov_b32 s15, 0
  s_sub_u32 s48, s42, 1
  s_cmp_lt_u32 s48, 13
  s_cselect_b32 s61, 0, 1
  s_cmp_ge_u32 s42, 14
  s_cselect_b32 s61, 2, s61
  s_lshl_b32 s58, s48, 7
  s_add_u32 s57, s42, 13
  s_lshl_b32 s57, s57, 7
  s_movk_i32 s49, 3456
  v_mad_u32_u24 v11, v24, s49, v25
  s_cmp_ge_u32 s42, 14
  s_cselect_b32 s50, 40, s49
  s_cselect_b32 s57, 0, s57
  s_lshl_b32 s60, s50, 6
  s_mul_i32 s26, s50, 640
  s_max_u32 s50, s50, 64
  v_mad_u32_u24 v10, v24, s50, v25
  s_lshl_b32 s48, s43, 6
  v_add_u32 v22, s48, v1
  v_mul_u32_u24 v23, 13108, v22
  v_lshrrev_b32 v23, 16, v23
  v_mul_u32_u24 v23, 1200, v23
  v_lshl_add_u32 v12, v22, 4, v23
  v_add_u32 v22, 256, v1
  v_mul_u32_u24 v23, 13108, v22
  v_lshrrev_b32 v23, 16, v23
  v_mul_u32_u24 v23, 1200, v23
  v_lshl_add_u32 v16, v22, 4, v23
  s_mul_i32 s59, s42, 80
  s_and_b32 s48, s42, 7
  s_mul_i32 s48, s48, 0
  s_and_b32 s49, s41, 3
  s_mul_i32 s49, s49, 10
  s_add_u32 s48, s48, s49
  s_lshr_b32 s3, s48, 2
  s_sub_u32 s48, s3, 10
  s_cselect_b32 s3, s3, s48
  s_lshl_b32 s48, s3, 7
  s_add_u32 s56, s56, s48
  s_mul_i32 s48, s60, s3
  s_add_u32 s57, s57, s48
  s_mul_i32 s48, s3, 221184
  s_add_u32 s58, s58, s48
  s_mul_i32 s48, s3, 81920
  s_add_u32 s59, s59, s48
  s_mov_b32 s23, 0x20000
  s_mov_b32 s27, 0x20000
  s_mov_b32 s31, 0x20000
  s_mov_b32 s35, 0x20000
  s_mov_b32 s39, 0x20000
  s_mov_b32 s22, 2621440
  s_mov_b32 s30, 2211840
  s_mov_b32 s34, 819200
  s_mov_b32 s38, 23592960
  s_lshl2_add_u32 s48, s2, s43
  s_cmp_lg_u32 s48, 0
  s_waitcnt lgkmcnt(0)
  s_cbranch_scc1 LF_nolead
  v_mov_b32 v48, s54
  v_mov_b32 v49, s55
  v_mov_b32 v50, 1
  v_mov_b32 v51, 0
  s_mov_b64 exec, 1
  global_store_dwordx4 v51, v[48:51], s[16:17] sc0 sc1
  s_mov_b64 exec, -1
LF_nolead:
  global_load_dwordx4 v[36:39], v32, s[4:5]
  global_load_dwordx4 v[40:43], v32, s[4:5] offset:512
  global_load_dwordx2 v[44:45], v33, s[4:5] offset:1024
  s_mov_b64 s[20:21], s[4:5]
  s_mov_b64 s[36:37], s[18:19]
  s_mov_b64 s[28:29], s[12:13]
  s_mov_b64 s[32:33], s[6:7]
  s_cmp_eq_u32 s42, 14
  s_cselect_b64 s[24:25], s[8:9], s[12:13]
  s_cmp_eq_u32 s42, 15
  s_cselect_b64 s[24:25], s[10:11], s[24:25]
  s_mov_b32 s46, 0
LF_zloop:
  s_add_u32 s48, s63, s15
  s_add_u32 s49, s14, s15
  s_mov_b32 m0, s48
  s_add_u32 s50, s56, 20480
  buffer_load_dwordx4 v8, s[20:23], s56 offen lds
  s_add_u32 m0, s48, 1024
  s_add_u32 s15, s15, 37888
  buffer_load_dwordx4 v9, s[20:23], s56 offen lds
  s_add_u32 m0, s48, 2048
  s_add_u32 s56, s56, 128
  buffer_load_dwordx4 v8, s[20:23], s50 offen lds
  s_add_u32 m0, s48, 3072
  s_cmp_eq_u32 s15, 151552
  buffer_load_dwordx4 v9, s[20:23], s50 offen lds
  s_cselect_b32 s15, 0, s15
  s_add_u32 m0, s49, 16384
  s_cmp_lg_u32 s43, 0
  buffer_load_dwordx4 v12, s[32:35], s59 offen lds
  s_cbranch_scc1 LF_noc2
  s_add_u32 m0, s49, 20480
  s_nop 0
  buffer_load_dwordx4 v16, s[32:35], s59 offen lds
LF_noc2:
  s_add_u32 s59, s59, 81920
  s_mov_b32 m0, s49
  s_cmp_eq_u32 s61, 2
  buffer_load_dwordx4 v10, s[24:27], s57 offen lds
  s_cbranch_scc1 LF_nab
  s_add_u32 m0, s49, 4032
  s_cmp_eq_u32 s61, 1
  buffer_load_dwordx4 v10, s[24:27], s57 offen offset:64 lds
  s_cbranch_scc1 LF_nab
  s_add_u32 m0, s49, 8192
  s_nop 0
  buffer_load_dwordx4 v11, s[28:31], s58 offen lds
  s_add_u32 m0, s49, 12224
  s_nop 0
  buffer_load_dwordx4 v11, s[28:31], s58 offen offset:64 lds
LF_nab:
  s_add_u32 s57, s57, s60
  s_add_u32 s58, s58, 221184
  s_add_u32 s3, s3, 1
  s_cmp_lg_u32 s3, 10
  s_cbranch_scc1 LF_nowrap
  s_sub_u32 s56, s56, 1280
  s_mul_i32 s48, s60, 10
  s_sub_u32 s57, s57, s48
  s_sub_u32 s58, s58, 2211840
  s_sub_u32 s59, s59, 819200
LF_nowrap:
  s_add_u32 s46, s46, 1
  s_cmp_eq_u32 s46, 2
  s_cbranch_scc1 LF_zfirst
  s_cmp_lt_u32 s46, 4
  s_cbranch_scc1 LF_zloop
  s_cmp_eq_u32 s46, 10
  s_cbranch_scc1 LF_ztail
  s_waitcnt vmcnt(18)
  s_cmp_eq_u32 s61, 0
  s_cbranch_scc1 LF_zw1
  s_waitcnt vmcnt(14)
  s_cmp_eq_u32 s61, 1
  s_cbranch_scc1 LF_zw1
  s_waitcnt vmcnt(12)
LF_zw1:
  s_barrier
  s_lshl2_add_u32 s48, s46, s43
  s_cmp_eq_u32 s48, 17
  s_cbranch_scc1 LF_zpub
  s_branch LF_zloop
LF_zfirst:
  v_mov_b32 v32, 0
  v_mov_b32 v33, 0
  v_mov_b32 v34, 0x3f803f80
  s_waitcnt vmcnt(18)
  s_cmp_eq_u32 s61, 0
  s_cbranch_scc1 LF_zw2
  s_waitcnt vmcnt(14)
  s_cmp_eq_u32 s61, 1
  s_cbranch_scc1 LF_zw2
  s_waitcnt vmcnt(12)
LF_zw2:
  v_dot2c_f32_bf16 v32, v36, v34
  v_dot2c_f32_bf16 v33, v36, v36
  v_dot2c_f32_bf16 v32, v37, v34
  v_dot2c_f32_bf16 v33, v37, v37
  v_dot2c_f32_bf16 v32, v38, v34
  v_dot2c_f32_bf16 v33, v38, v38
  v_dot2c_f32_bf16 v32, v39, v34
  v_dot2c_f32_bf16 v33, v39, v39
  v_dot2c_f32_bf16 v32, v40, v34
  v_dot2c_f32_bf16 v33, v40, v40
  v_dot2c_f32_bf16 v32, v41, v34
  v_dot2c_f32_bf16 v33, v41, v41
  v_dot2c_f32_bf16 v32, v42, v34
  v_dot2c_f32_bf16 v33, v42, v42
  v_dot2c_f32_bf16 v32, v43, v34
  v_dot2c_f32_bf16 v33, v43, v43
  v_dot2c_f32_bf16 v32, v44, v34
  v_dot2c_f32_bf16 v33, v44, v44
  v_dot2c_f32_bf16 v32, v45, v34
  v_dot2c_f32_bf16 v33, v45, v45
  s_nop 2
  ds_swizzle_b32 v34, v32 offset:1055
  ds_swizzle_b32 v35, v33 offset:1055
  s_waitcnt lgkmcnt(0)
  v_add_f32 v32, v32, v34
  v_add_f32 v33, v33, v35
  ds_swizzle_b32 v34, v32 offset:2079
  ds_swizzle_b32 v35, v33 offset:2079
  s_waitcnt lgkmcnt(0)
  v_add_f32 v32, v32, v34
  v_add_f32 v33, v33, v35
  ds_swizzle_b32 v34, v32 offset:4127
  ds_swizzle_b32 v35, v33 offset:4127
  s_waitcnt lgkmcnt(0)
  v_add_f32 v32, v32, v34
  v_add_f32 v33, v33, v35
  ds_swizzle_b32 v34, v32 offset:8223
  ds_swizzle_b32 v35, v33 offset:8223
  s_waitcnt lgkmcnt(0)
  v_add_f32 v32, v32, v34
  v_add_f32 v33, v33, v35
  ds_swizzle_b32 v34, v32 offset:16415
  ds_swizzle_b32 v35, v33 offset:16415
  s_waitcnt lgkmcnt(0)
  v_add_f32 v32, v32, v34
  v_add_f32 v33, v33, v35
  v_mul_f32 v32, 0x3acccccd, v32
  v_mul_f32 v33, 0x3acccccd, v33
  s_lshl_b32 s48, s43, 4
  s_add_u32 s48, s48, 160512
  v_lshrrev_b32 v36, 5, v1
  v_lshl_add_u32 v36, v36, 3, s48
  v_cvt_pk_bf16_f32 v34, -v32, -v32
  v_fma_f32 v33, -v32, v32, v33
  v_max_f32 v33, 0, v33
  v_add_f32 v33, 0x3727c5ac, v33
  v_rsq_f32 v35, v33
  s_nop 0
  ds_write_b64 v36, v[34:35]
  s_waitcnt lgkmcnt(0)
  s_cmp_lg_u32 s43, 1
  s_cbranch_scc1 LF_zf1
  global_load_dwordx4 v[160:163], v14, s[16:17] sc0 sc1
  s_waitcnt vmcnt(10)
  s_cmp_eq_u32 s61, 0
  s_cbranch_scc1 LF_zw3
  s_waitcnt vmcnt(8)
  s_cmp_eq_u32 s61, 1
  s_cbranch_scc1 LF_zw3
  s_waitcnt vmcnt(7)
LF_zw3:
  s_barrier
  s_branch LF_zloop
LF_zf1:
  s_waitcnt vmcnt(9)
  s_cmp_eq_u32 s61, 0
  s_cbranch_scc1 LF_zw4
  s_waitcnt vmcnt(7)
  s_cmp_eq_u32 s61, 1
  s_cbranch_scc1 LF_zw4
  s_waitcnt vmcnt(6)
LF_zw4:
  s_barrier
  s_branch LF_zloop
LF_zpub:
  v_add_u32 v22, 160512, v3
  ds_read_b64 v[24:25], v22
  s_mov_b32 s49, 0x20000
LF_npoll:
  v_cmp_eq_u32 vcc, 1, v162
  s_nop 0
  s_cbranch_vccnz LF_ngot
  global_load_dwordx4 v[160:163], v14, s[16:17] sc0 sc1
  s_waitcnt vmcnt(0)
  s_sub_u32 s49, s49, 1
  s_cbranch_scc0 LF_npoll
LF_ngot:
  v_mov_b32 v22, 160256
  ds_write_b64 v22, v[160:161]
  v_mov_b32 v26, v160
  v_mov_b32 v27, v161
  s_lshl_b32 s48, s41, 11
  s_lshl_b32 s49, s42, 7
  s_add_u32 s48, s48, s49
  s_add_u32 s48, s48, 19529728
  s_waitcnt lgkmcnt(0)
  s_mov_b64 exec, 0xff
  buffer_store_dwordx4 v[24:27], v2, s[36:39], s48 offen sc0 sc1
  s_mov_b64 exec, -1
  s_branch LF_zloop
LF_A:
  s_and_b32 s48, s45, 3
  s_cbranch_scc1 LF_ncp
  s_getpc_b64 s[54:55]
Lpc_parallel_sum__grouped_kv_mqa__mixer_gmlp__prompt_kernel:
  s_sub_u32 s54, s54, Lpc_parallel_sum__grouped_kv_mqa__mixer_gmlp__prompt_kernel-parallel_sum__grouped_kv_mqa__mixer_gmlp__prompt_kernel
  s_subb_u32 s55, s55, 0
  v_lshlrev_b32 v152, 7, v1
  v_lshl_add_u32 v152, v16, 13, v152
  v_min_u32 v152, Lcode_end-parallel_sum__grouped_kv_mqa__mixer_gmlp__prompt_kernel-4, v152
  global_load_dword v5, v152, s[54:55]
LF_ncp:
  s_mov_b32 s52, 0
  s_mov_b32 s53, -1
  s_lshl_b32 s48, s40, 8
  s_add_u32 s48, s48, 161792
  v_lshl_add_u32 v4, v1, 2, s48
  v_mov_b32 v64, 0
  v_mov_b32 v65, 0
  v_mov_b32 v66, 0
  v_mov_b32 v67, 0
  v_mov_b32 v68, 0
  v_mov_b32 v69, 0
  v_mov_b32 v70, 0
  v_mov_b32 v71, 0
  v_mov_b32 v72, 0
  v_mov_b32 v73, 0
  v_mov_b32 v74, 0
  v_mov_b32 v75, 0
  v_mov_b32 v76, 0
  v_mov_b32 v77, 0
  v_mov_b32 v78, 0
  v_mov_b32 v79, 0
  v_mov_b32 v80, 0
  v_mov_b32 v81, 0
  v_mov_b32 v82, 0
  v_mov_b32 v83, 0
  v_mov_b32 v84, 0
  v_mov_b32 v85, 0
  v_mov_b32 v86, 0
  v_mov_b32 v87, 0
  v_mov_b32 v88, 0
  v_mov_b32 v89, 0
  v_mov_b32 v90, 0
  v_mov_b32 v91, 0
  v_mov_b32 v92, 0
  v_mov_b32 v93, 0
  v_mov_b32 v94, 0
  v_mov_b32 v95, 0
  v_mov_b32 v96, 0
  v_mov_b32 v97, 0
  v_mov_b32 v98, 0
  v_mov_b32 v99, 0
  v_mov_b32 v100, 0
  v_mov_b32 v101, 0
  v_mov_b32 v102, 0
  v_mov_b32 v103, 0
  v_mov_b32 v104, 0
  v_mov_b32 v105, 0
  v_mov_b32 v106, 0
  v_mov_b32 v107, 0
  v_mov_b32 v108, 0
  v_mov_b32 v109, 0
  v_mov_b32 v110, 0
  v_mov_b32 v111, 0
  v_mov_b32 v112, 0
  v_mov_b32 v113, 0
  v_mov_b32 v114, 0
  v_mov_b32 v115, 0
  v_mov_b32 v116, 0
  v_mov_b32 v117, 0
  v_mov_b32 v118, 0
  v_mov_b32 v119, 0
  v_mov_b32 v120, 0
  v_mov_b32 v121, 0
  v_mov_b32 v122, 0
  v_mov_b32 v123, 0
  v_mov_b32 v124, 0
  v_mov_b32 v125, 0
  v_mov_b32 v126, 0
  v_mov_b32 v127, 0
  v_mov_b32 v128, 0
  v_mov_b32 v129, 0
  v_mov_b32 v130, 0
  v_mov_b32 v131, 0
  v_mov_b32 v132, 0
  v_mov_b32 v133, 0
  v_mov_b32 v134, 0
  v_mov_b32 v135, 0
  ds_write_b32 v4, v128
  s_and_b32 s48, s40, 1
  s_lshl_b32 s48, s48, 1
  s_lshr_b32 s49, s40, 1
  s_cmp_ge_u32 s42, 14
  s_cselect_b32 s48, s43, s48
  s_cselect_b32 s49, 0, s49
  s_cmp_lt_u32 s40, 4
  s_cselect_b32 s48, s48, s43
  s_cselect_b32 s49, s49, 4
  v_and_b32 v32, 31, v1
  v_lshrrev_b32 v33, 5, v1
  v_mov_b32 v34, s48
  v_lshl_add_u32 v35, v34, 5, v32
  v_lshl_add_u32 v36, v34, 1, v33
  v_bfe_u32 v37, v32, 1, 3
  v_xor_b32 v36, v36, v37
  v_lshlrev_b32 v36, 4, v36
  v_lshl_add_u32 v8, v35, 7, v36
  v_xor_b32 v9, 32, v8
  v_xor_b32 v10, 64, v8
  v_xor_b32 v11, 96, v8
  v_lshlrev_b32 v35, 10, v34
  v_lshl_add_u32 v35, v33, 9, v35
  v_bfe_u32 v36, v1, 2, 2
  v_lshl_add_u32 v35, v36, 6, v35
  v_bfe_u32 v36, v1, 4, 1
  v_lshl_add_u32 v35, v36, 5, v35
  v_and_b32 v37, 3, v1
  v_lshl_add_u32 v35, v37, 3, v35
  s_lshl_b32 s48, s49, 12
  s_add_u32 s48, s48, 16384
  v_add_u32 v12, s48, v35
  v_xor_b32 v13, 1024, v12
  v_xor_b32 v14, 2048, v12
  v_xor_b32 v15, 3072, v12
  s_lshl_b32 s59, s49, 9
  s_add_u32 s59, s59, 151552
  v_and_b32 v17, 15, v1
  v_cmp_eq_u32 vcc, v36, v17
  v_mov_b32 v17, 0x3f803f80
  v_mov_b32 v28, 0xbdd2d3e8
  v_cndmask_b32 v16, 0, v17, vcc
  v_mov_b32 v29, 0xc0135761
  v_mov_b32 v17, v16
  v_mov_b32 v18, v16
  v_mov_b32 v19, v16
  s_mov_b32 s49, 37888
  s_mov_b32 s50, -113664
  s_waitcnt lgkmcnt(0)
  s_mov_b32 s36, s18
  s_mov_b32 s37, s19
  s_mov_b32 s38, 23592960
  s_mov_b32 s39, 0x20000
  s_cmp_ge_u32 s40, 4
  s_cbranch_scc1 LF_S
  s_sub_u32 s48, s42, 1
  s_cmp_lt_u32 s48, 13
  s_cbranch_scc0 LF_Pl
  s_barrier
  ds_read_b128 v[32:35], v8 offset:0
  ds_read_b64_tr_b16 v[40:41], v12 offset:0
  ds_read_b64_tr_b16 v[42:43], v12 offset:256
  ds_read_b128 v[36:39], v8 offset:4096
  ds_read_b64_tr_b16 v[44:45], v12 offset:8192
  ds_read_b64_tr_b16 v[46:47], v12 offset:8448
  ds_read_b128 v[48:51], v9 offset:0
  ds_read_b64_tr_b16 v[56:57], v13 offset:0
  ds_read_b64_tr_b16 v[58:59], v13 offset:256
  ds_read_b128 v[52:55], v9 offset:4096
  ds_read_b64_tr_b16 v[60:61], v13 offset:8192
  ds_read_b64_tr_b16 v[62:63], v13 offset:8448
  s_mov_b32 s46, 0
.p2align 6
LF_loopp:
  s_add_u32 s46, s46, 1
  s_and_b32 s48, s46, 3
  s_cselect_b32 s48, s49, s50
  s_waitcnt lgkmcnt(6)
  v_mfma_f32_32x32x16_bf16 v[64:79], v[40:43], v[32:35], v[64:79]
  ds_read_b128 v[136:139], v10 offset:0
  ds_read_b64_tr_b16 v[144:145], v14 offset:0
  v_mfma_f32_32x32x16_bf16 v[80:95], v[40:43], v[36:39], v[80:95]
  ds_read_b64_tr_b16 v[146:147], v14 offset:256
  ds_read_b128 v[140:143], v10 offset:4096
  v_mfma_f32_16x16x32_bf16 v[128:131], v[40:43], v[16:19], v[128:131]
  v_mfma_f32_32x32x16_bf16 v[96:111], v[44:47], v[32:35], v[96:111]
  ds_read_b64_tr_b16 v[148:149], v14 offset:8192
  ds_read_b64_tr_b16 v[150:151], v14 offset:8448
  v_mfma_f32_32x32x16_bf16 v[112:127], v[44:47], v[36:39], v[112:127]
  v_add_u32 v8, s48, v8
  v_add_u32 v12, s48, v12
  v_mfma_f32_16x16x32_bf16 v[132:135], v[44:47], v[16:19], v[132:135]
  v_add_u32 v9, s48, v9
  v_add_u32 v13, s48, v13
  s_waitcnt lgkmcnt(6)
  v_mfma_f32_32x32x16_bf16 v[64:79], v[56:59], v[48:51], v[64:79]
  ds_read_b128 v[152:155], v11 offset:0
  ds_read_b64_tr_b16 v[160:161], v15 offset:0
  v_mfma_f32_32x32x16_bf16 v[80:95], v[56:59], v[52:55], v[80:95]
  ds_read_b64_tr_b16 v[162:163], v15 offset:256
  ds_read_b128 v[156:159], v11 offset:4096
  v_mfma_f32_16x16x32_bf16 v[128:131], v[56:59], v[16:19], v[128:131]
  v_mfma_f32_32x32x16_bf16 v[96:111], v[60:63], v[48:51], v[96:111]
  ds_read_b64_tr_b16 v[164:165], v15 offset:8192
  ds_read_b64_tr_b16 v[166:167], v15 offset:8448
  v_mfma_f32_32x32x16_bf16 v[112:127], v[60:63], v[52:55], v[112:127]
  v_add_u32 v10, s48, v10
  v_add_u32 v14, s48, v14
  v_mfma_f32_16x16x32_bf16 v[132:135], v[60:63], v[16:19], v[132:135]
  v_add_u32 v11, s48, v11
  v_add_u32 v15, s48, v15
  s_waitcnt lgkmcnt(0)
  s_barrier
  v_mfma_f32_32x32x16_bf16 v[64:79], v[144:147], v[136:139], v[64:79]
  ds_read_b128 v[32:35], v8 offset:0
  ds_read_b64_tr_b16 v[40:41], v12 offset:0
  v_mfma_f32_32x32x16_bf16 v[80:95], v[144:147], v[140:143], v[80:95]
  ds_read_b64_tr_b16 v[42:43], v12 offset:256
  ds_read_b128 v[36:39], v8 offset:4096
  v_mfma_f32_32x32x16_bf16 v[96:111], v[148:151], v[136:139], v[96:111]
  ds_read_b64_tr_b16 v[44:45], v12 offset:8192
  ds_read_b64_tr_b16 v[46:47], v12 offset:8448
  v_mfma_f32_32x32x16_bf16 v[112:127], v[148:151], v[140:143], v[112:127]
  v_mfma_f32_32x32x16_bf16 v[64:79], v[160:163], v[152:155], v[64:79]
  ds_read_b128 v[48:51], v9 offset:0
  ds_read_b64_tr_b16 v[56:57], v13 offset:0
  v_mfma_f32_32x32x16_bf16 v[80:95], v[160:163], v[156:159], v[80:95]
  ds_read_b64_tr_b16 v[58:59], v13 offset:256
  ds_read_b128 v[52:55], v9 offset:4096
  v_mfma_f32_32x32x16_bf16 v[96:111], v[164:167], v[152:155], v[96:111]
  ds_read_b64_tr_b16 v[60:61], v13 offset:8192
  ds_read_b64_tr_b16 v[62:63], v13 offset:8448
  v_mfma_f32_32x32x16_bf16 v[112:127], v[164:167], v[156:159], v[112:127]
  s_cmp_lt_u32 s46, 10
  s_cbranch_scc1 LF_loopp
  s_waitcnt lgkmcnt(0)
  s_branch LF_Pe
LF_Pl:
  s_cmp_eq_u32 s42, 0
  s_cbranch_scc0 LF_Pk
  s_barrier
  ds_read_b128 v[32:35], v8 offset:0
  ds_read_b64_tr_b16 v[40:41], v12 offset:0
  ds_read_b64_tr_b16 v[42:43], v12 offset:256
  ds_read_b128 v[36:39], v8 offset:4096
  ds_read_b128 v[48:51], v9 offset:0
  ds_read_b64_tr_b16 v[56:57], v13 offset:0
  ds_read_b64_tr_b16 v[58:59], v13 offset:256
  ds_read_b128 v[52:55], v9 offset:4096
  s_mov_b32 s46, 0
.p2align 6
LF_loopl:
  s_add_u32 s46, s46, 1
  s_and_b32 s48, s46, 3
  s_cselect_b32 s48, s49, s50
  s_waitcnt lgkmcnt(4)
  v_mfma_f32_32x32x16_bf16 v[64:79], v[40:43], v[32:35], v[64:79]
  ds_read_b128 v[136:139], v10 offset:0
  ds_read_b64_tr_b16 v[144:145], v14 offset:0
  ds_read_b64_tr_b16 v[146:147], v14 offset:256
  v_mfma_f32_32x32x16_bf16 v[80:95], v[40:43], v[36:39], v[80:95]
  ds_read_b128 v[140:143], v10 offset:4096
  v_add_u32 v8, s48, v8
  v_add_u32 v12, s48, v12
  v_mfma_f32_16x16x32_bf16 v[128:131], v[40:43], v[16:19], v[128:131]
  v_add_u32 v9, s48, v9
  v_add_u32 v13, s48, v13
  s_waitcnt lgkmcnt(4)
  v_mfma_f32_32x32x16_bf16 v[64:79], v[56:59], v[48:51], v[64:79]
  ds_read_b128 v[152:155], v11 offset:0
  ds_read_b64_tr_b16 v[160:161], v15 offset:0
  ds_read_b64_tr_b16 v[162:163], v15 offset:256
  v_mfma_f32_32x32x16_bf16 v[80:95], v[56:59], v[52:55], v[80:95]
  ds_read_b128 v[156:159], v11 offset:4096
  v_add_u32 v10, s48, v10
  v_add_u32 v14, s48, v14
  v_mfma_f32_16x16x32_bf16 v[128:131], v[56:59], v[16:19], v[128:131]
  v_add_u32 v11, s48, v11
  v_add_u32 v15, s48, v15
  s_waitcnt lgkmcnt(0)
  s_barrier
  v_mfma_f32_32x32x16_bf16 v[64:79], v[144:147], v[136:139], v[64:79]
  ds_read_b128 v[32:35], v8 offset:0
  ds_read_b64_tr_b16 v[40:41], v12 offset:0
  ds_read_b64_tr_b16 v[42:43], v12 offset:256
  v_mfma_f32_32x32x16_bf16 v[80:95], v[144:147], v[140:143], v[80:95]
  ds_read_b128 v[36:39], v8 offset:4096
  v_mfma_f32_32x32x16_bf16 v[64:79], v[160:163], v[152:155], v[64:79]
  ds_read_b128 v[48:51], v9 offset:0
  ds_read_b64_tr_b16 v[56:57], v13 offset:0
  ds_read_b64_tr_b16 v[58:59], v13 offset:256
  v_mfma_f32_32x32x16_bf16 v[80:95], v[160:163], v[156:159], v[80:95]
  ds_read_b128 v[52:55], v9 offset:4096
  s_cmp_lt_u32 s46, 10
  s_cbranch_scc1 LF_loopl
  s_waitcnt lgkmcnt(0)
LF_Pe:
  s_and_b32 s51, s40, 1
  v_and_b32 v136, 1, v1
  v_lshlrev_b32 v136, 8, v136
  v_lshrrev_b32 v137, 4, v1
  v_lshl_add_u32 v136, v137, 6, v136
  s_lshl2_add_u32 s48, s51, s59
  v_add_u32 v136, s48, v136
  v_cvt_pk_bf16_f32 v138, v128, v128
  v_cvt_pk_bf16_f32 v139, v129, v129
  v_cvt_pk_bf16_f32 v140, v130, v130
  v_cvt_pk_bf16_f32 v141, v131, v131
  v_cvt_pk_bf16_f32 v142, v132, v132
  v_cvt_pk_bf16_f32 v143, v133, v133
  v_cvt_pk_bf16_f32 v144, v134, v134
  v_cvt_pk_bf16_f32 v145, v135, v135
  v_lshlrev_b32 v138, 16, v138
  v_lshlrev_b32 v139, 16, v139
  v_lshlrev_b32 v140, 16, v140
  v_lshlrev_b32 v141, 16, v141
  v_lshlrev_b32 v142, 16, v142
  v_lshlrev_b32 v143, 16, v143
  v_lshlrev_b32 v144, 16, v144
  v_lshlrev_b32 v145, 16, v145
  v_sub_f32 v138, v128, v138
  v_sub_f32 v139, v129, v139
  v_sub_f32 v140, v130, v140
  v_sub_f32 v141, v131, v141
  v_sub_f32 v142, v132, v142
  v_sub_f32 v143, v133, v143
  v_sub_f32 v144, v134, v144
  v_sub_f32 v145, v135, v145
  v_cvt_pk_bf16_f32 v138, v128, v138
  v_cvt_pk_bf16_f32 v139, v129, v139
  v_cvt_pk_bf16_f32 v140, v130, v140
  v_cvt_pk_bf16_f32 v141, v131, v141
  v_cvt_pk_bf16_f32 v142, v132, v142
  v_cvt_pk_bf16_f32 v143, v133, v143
  v_cvt_pk_bf16_f32 v144, v134, v144
  v_cvt_pk_bf16_f32 v145, v135, v145
  s_mov_b32 exec_lo, 0x00030003
  s_mov_b32 exec_hi, 0x00030003
  ds_write_b32 v136, v138 offset:0
  ds_write_b32 v136, v139 offset:16
  ds_write_b32 v136, v140 offset:32
  ds_write_b32 v136, v141 offset:48
  ds_write_b32 v136, v142 offset:1024
  ds_write_b32 v136, v143 offset:1040
  ds_write_b32 v136, v144 offset:1056
  ds_write_b32 v136, v145 offset:1072
  s_mov_b64 exec, -1
  s_lshr_b32 s50, s40, 1
  s_lshl_b32 s47, s41, 2
  s_lshl1_add_u32 s47, s51, s47
  v_and_b32 v136, 0x1f0, v2
  v_add_u32 v136, s59, v136
  v_and_b32 v137, 0xf8, v3
  s_lshl_b32 s48, s51, 9
  s_add_u32 s48, s48, 154624
  v_add_u32 v137, s48, v137
  v_mov_b32 v142, 160256
  s_lshl_b32 s48, s51, 13
  s_lshl_b32 s49, s50, 11
  s_add_u32 s48, s48, s49
  s_add_u32 s48, s48, 81920
  v_add_u32 v6, s48, v2
  s_or_b32 s48, s42, s50
  s_cselect_b32 s48, -32768, 0
  v_add_u32 v7, s48, v6
  v_mov_b32 v160, 1
  s_setprio 3
  s_waitcnt lgkmcnt(0)
  s_barrier
  ds_read_b64 v[138:139], v137
  ds_read_b64 v[140:141], v137 offset:256
  ds_read_b64 v[32:33], v136 offset:0
  v_mov_b32 v34, 0
  v_mov_b32 v35, 0
  ds_read_b64 v[36:37], v136 offset:1024
  v_mov_b32 v38, 0
  v_mov_b32 v39, 0
  ds_read_b64 v[30:31], v142
  s_waitcnt lgkmcnt(3)
  v_cndmask_b32 v20, v138, 0, s[52:53]
  v_mov_b32 v24, v139
  v_mov_b32 v21, v20
  v_mov_b32 v22, v20
  v_mov_b32 v23, v20
  v_cndmask_b32 v48, v140, 0, s[52:53]
  v_mov_b32 v26, v141
  v_mov_b32 v49, v48
  v_mov_b32 v50, v48
  v_mov_b32 v51, v48
  s_waitcnt lgkmcnt(0)
  s_nop 0
  v_mfma_f32_32x32x16_bf16 v[64:79], v[32:35], v[20:23], v[64:79]
  v_mfma_f32_32x32x16_bf16 v[80:95], v[32:35], v[48:51], v[80:95]
  v_mfma_f32_32x32x16_bf16 v[96:111], v[36:39], v[20:23], v[96:111]
  v_mfma_f32_32x32x16_bf16 v[112:127], v[36:39], v[48:51], v[112:127]
  s_mov_b32 s58, 0
  s_nop 7
LF_pg:
  v_pk_mul_f32 v[64:65], v[64:65], v[24:25] op_sel_hi:[1,0]
  v_pk_mul_f32 v[66:67], v[66:67], v[24:25] op_sel_hi:[1,0]
  v_pk_mul_f32 v[68:69], v[68:69], v[24:25] op_sel_hi:[1,0]
  v_pk_mul_f32 v[70:71], v[70:71], v[24:25] op_sel_hi:[1,0]
  v_pk_mul_f32 v[72:73], v[72:73], v[24:25] op_sel_hi:[1,0]
  v_pk_mul_f32 v[74:75], v[74:75], v[24:25] op_sel_hi:[1,0]
  v_pk_mul_f32 v[76:77], v[76:77], v[24:25] op_sel_hi:[1,0]
  v_pk_mul_f32 v[78:79], v[78:79], v[24:25] op_sel_hi:[1,0]
  v_pk_mul_f32 v[136:137], v[64:65], v[64:65]
  v_pk_mul_f32 v[138:139], v[66:67], v[66:67]
  v_pk_mul_f32 v[140:141], v[68:69], v[68:69]
  v_pk_mul_f32 v[142:143], v[70:71], v[70:71]
  v_pk_mul_f32 v[144:145], v[72:73], v[72:73]
  v_pk_mul_f32 v[146:147], v[74:75], v[74:75]
  v_pk_mul_f32 v[148:149], v[76:77], v[76:77]
  v_pk_mul_f32 v[150:151], v[78:79], v[78:79]
  v_pk_fma_f32 v[136:137], v[136:137], v[28:29], v[28:29] op_sel:[0,0,1] op_sel_hi:[1,0,1]
  v_pk_fma_f32 v[138:139], v[138:139], v[28:29], v[28:29] op_sel:[0,0,1] op_sel_hi:[1,0,1]
  v_pk_fma_f32 v[140:141], v[140:141], v[28:29], v[28:29] op_sel:[0,0,1] op_sel_hi:[1,0,1]
  v_pk_fma_f32 v[142:143], v[142:143], v[28:29], v[28:29] op_sel:[0,0,1] op_sel_hi:[1,0,1]
  v_pk_fma_f32 v[144:145], v[144:145], v[28:29], v[28:29] op_sel:[0,0,1] op_sel_hi:[1,0,1]
  v_pk_fma_f32 v[146:147], v[146:147], v[28:29], v[28:29] op_sel:[0,0,1] op_sel_hi:[1,0,1]
  v_pk_fma_f32 v[148:149], v[148:149], v[28:29], v[28:29] op_sel:[0,0,1] op_sel_hi:[1,0,1]
  v_pk_fma_f32 v[150:151], v[150:151], v[28:29], v[28:29] op_sel:[0,0,1] op_sel_hi:[1,0,1]
  v_pk_mul_f32 v[136:137], v[136:137], v[64:65]
  v_pk_mul_f32 v[138:139], v[138:139], v[66:67]
  v_pk_mul_f32 v[140:141], v[140:141], v[68:69]
  v_pk_mul_f32 v[142:143], v[142:143], v[70:71]
  v_pk_mul_f32 v[144:145], v[144:145], v[72:73]
  v_pk_mul_f32 v[146:147], v[146:147], v[74:75]
  v_pk_mul_f32 v[148:149], v[148:149], v[76:77]
  v_pk_mul_f32 v[150:151], v[150:151], v[78:79]
  v_exp_f32 v136, v136
  v_exp_f32 v137, v137
  v_exp_f32 v138, v138
  v_exp_f32 v139, v139
  v_exp_f32 v140, v140
  v_exp_f32 v141, v141
  v_exp_f32 v142, v142
  v_exp_f32 v143, v143
  v_exp_f32 v144, v144
  v_exp_f32 v145, v145
  v_exp_f32 v146, v146
  v_exp_f32 v147, v147
  v_exp_f32 v148, v148
  v_exp_f32 v149, v149
  v_exp_f32 v150, v150
  v_exp_f32 v151, v151
  v_pk_add_f32 v[136:137], v[136:137], 1.0 op_sel_hi:[1,0]
  v_pk_add_f32 v[138:139], v[138:139], 1.0 op_sel_hi:[1,0]
  v_pk_add_f32 v[140:141], v[140:141], 1.0 op_sel_hi:[1,0]
  v_pk_add_f32 v[142:143], v[142:143], 1.0 op_sel_hi:[1,0]
  v_pk_add_f32 v[144:145], v[144:145], 1.0 op_sel_hi:[1,0]
  v_pk_add_f32 v[146:147], v[146:147], 1.0 op_sel_hi:[1,0]
  v_pk_add_f32 v[148:149], v[148:149], 1.0 op_sel_hi:[1,0]
  v_pk_add_f32 v[150:151], v[150:151], 1.0 op_sel_hi:[1,0]
  v_rcp_f32 v136, v136
  v_rcp_f32 v137, v137
  v_rcp_f32 v138, v138
  v_rcp_f32 v139, v139
  v_rcp_f32 v140, v140
  v_rcp_f32 v141, v141
  v_rcp_f32 v142, v142
  v_rcp_f32 v143, v143
  v_rcp_f32 v144, v144
  v_rcp_f32 v145, v145
  v_rcp_f32 v146, v146
  v_rcp_f32 v147, v147
  v_rcp_f32 v148, v148
  v_rcp_f32 v149, v149
  v_rcp_f32 v150, v150
  v_rcp_f32 v151, v151
  v_pk_mul_f32 v[64:65], v[64:65], v[136:137]
  v_pk_mul_f32 v[66:67], v[66:67], v[138:139]
  v_pk_mul_f32 v[68:69], v[68:69], v[140:141]
  v_pk_mul_f32 v[70:71], v[70:71], v[142:143]
  v_pk_mul_f32 v[72:73], v[72:73], v[144:145]
  v_pk_mul_f32 v[74:75], v[74:75], v[146:147]
  v_pk_mul_f32 v[76:77], v[76:77], v[148:149]
  v_pk_mul_f32 v[78:79], v[78:79], v[150:151]
  v_cvt_pk_bf16_f32 v152, v64, v65
  v_cvt_pk_bf16_f32 v153, v66, v67
  v_cvt_pk_bf16_f32 v154, v68, v69
  v_cvt_pk_bf16_f32 v155, v70, v71
  v_cvt_pk_bf16_f32 v156, v72, v73
  v_cvt_pk_bf16_f32 v157, v74, v75
  v_cvt_pk_bf16_f32 v158, v76, v77
  v_cvt_pk_bf16_f32 v159, v78, v79
  ds_write_b128 v7, v[152:155] offset:0
  ds_write_b128 v7, v[156:159] offset:1024
  v_pk_mul_f32 v[80:81], v[80:81], v[26:27] op_sel_hi:[1,0]
  v_pk_mul_f32 v[82:83], v[82:83], v[26:27] op_sel_hi:[1,0]
  v_pk_mul_f32 v[84:85], v[84:85], v[26:27] op_sel_hi:[1,0]
  v_pk_mul_f32 v[86:87], v[86:87], v[26:27] op_sel_hi:[1,0]
  v_pk_mul_f32 v[88:89], v[88:89], v[26:27] op_sel_hi:[1,0]
  v_pk_mul_f32 v[90:91], v[90:91], v[26:27] op_sel_hi:[1,0]
  v_pk_mul_f32 v[92:93], v[92:93], v[26:27] op_sel_hi:[1,0]
  v_pk_mul_f32 v[94:95], v[94:95], v[26:27] op_sel_hi:[1,0]
  v_pk_mul_f32 v[136:137], v[80:81], v[80:81]
  v_pk_mul_f32 v[138:139], v[82:83], v[82:83]
  v_pk_mul_f32 v[140:141], v[84:85], v[84:85]
  v_pk_mul_f32 v[142:143], v[86:87], v[86:87]
  v_pk_mul_f32 v[144:145], v[88:89], v[88:89]
  v_pk_mul_f32 v[146:147], v[90:91], v[90:91]
  v_pk_mul_f32 v[148:149], v[92:93], v[92:93]
  v_pk_mul_f32 v[150:151], v[94:95], v[94:95]
  v_pk_fma_f32 v[136:137], v[136:137], v[28:29], v[28:29] op_sel:[0,0,1] op_sel_hi:[1,0,1]
  v_pk_fma_f32 v[138:139], v[138:139], v[28:29], v[28:29] op_sel:[0,0,1] op_sel_hi:[1,0,1]
  v_pk_fma_f32 v[140:141], v[140:141], v[28:29], v[28:29] op_sel:[0,0,1] op_sel_hi:[1,0,1]
  v_pk_fma_f32 v[142:143], v[142:143], v[28:29], v[28:29] op_sel:[0,0,1] op_sel_hi:[1,0,1]
  v_pk_fma_f32 v[144:145], v[144:145], v[28:29], v[28:29] op_sel:[0,0,1] op_sel_hi:[1,0,1]
  v_pk_fma_f32 v[146:147], v[146:147], v[28:29], v[28:29] op_sel:[0,0,1] op_sel_hi:[1,0,1]
  v_pk_fma_f32 v[148:149], v[148:149], v[28:29], v[28:29] op_sel:[0,0,1] op_sel_hi:[1,0,1]
  v_pk_fma_f32 v[150:151], v[150:151], v[28:29], v[28:29] op_sel:[0,0,1] op_sel_hi:[1,0,1]
  v_pk_mul_f32 v[136:137], v[136:137], v[80:81]
  v_pk_mul_f32 v[138:139], v[138:139], v[82:83]
  v_pk_mul_f32 v[140:141], v[140:141], v[84:85]
  v_pk_mul_f32 v[142:143], v[142:143], v[86:87]
  v_pk_mul_f32 v[144:145], v[144:145], v[88:89]
  v_pk_mul_f32 v[146:147], v[146:147], v[90:91]
  v_pk_mul_f32 v[148:149], v[148:149], v[92:93]
  v_pk_mul_f32 v[150:151], v[150:151], v[94:95]
  v_exp_f32 v136, v136
  v_exp_f32 v137, v137
  v_exp_f32 v138, v138
  v_exp_f32 v139, v139
  v_exp_f32 v140, v140
  v_exp_f32 v141, v141
  v_exp_f32 v142, v142
  v_exp_f32 v143, v143
  v_exp_f32 v144, v144
  v_exp_f32 v145, v145
  v_exp_f32 v146, v146
  v_exp_f32 v147, v147
  v_exp_f32 v148, v148
  v_exp_f32 v149, v149
  v_exp_f32 v150, v150
  v_exp_f32 v151, v151
  v_pk_add_f32 v[136:137], v[136:137], 1.0 op_sel_hi:[1,0]
  v_pk_add_f32 v[138:139], v[138:139], 1.0 op_sel_hi:[1,0]
  v_pk_add_f32 v[140:141], v[140:141], 1.0 op_sel_hi:[1,0]
  v_pk_add_f32 v[142:143], v[142:143], 1.0 op_sel_hi:[1,0]
  v_pk_add_f32 v[144:145], v[144:145], 1.0 op_sel_hi:[1,0]
  v_pk_add_f32 v[146:147], v[146:147], 1.0 op_sel_hi:[1,0]
  v_pk_add_f32 v[148:149], v[148:149], 1.0 op_sel_hi:[1,0]
  v_pk_add_f32 v[150:151], v[150:151], 1.0 op_sel_hi:[1,0]
  v_rcp_f32 v136, v136
  v_rcp_f32 v137, v137
  v_rcp_f32 v138, v138
  v_rcp_f32 v139, v139
  v_rcp_f32 v140, v140
  v_rcp_f32 v141, v141
  v_rcp_f32 v142, v142
  v_rcp_f32 v143, v143
  v_rcp_f32 v144, v144
  v_rcp_f32 v145, v145
  v_rcp_f32 v146, v146
  v_rcp_f32 v147, v147
  v_rcp_f32 v148, v148
  v_rcp_f32 v149, v149
  v_rcp_f32 v150, v150
  v_rcp_f32 v151, v151
  v_pk_mul_f32 v[80:81], v[80:81], v[136:137]
  v_pk_mul_f32 v[82:83], v[82:83], v[138:139]
  v_pk_mul_f32 v[84:85], v[84:85], v[140:141]
  v_pk_mul_f32 v[86:87], v[86:87], v[142:143]
  v_pk_mul_f32 v[88:89], v[88:89], v[144:145]
  v_pk_mul_f32 v[90:91], v[90:91], v[146:147]
  v_pk_mul_f32 v[92:93], v[92:93], v[148:149]
  v_pk_mul_f32 v[94:95], v[94:95], v[150:151]
  v_cvt_pk_bf16_f32 v152, v80, v81
  v_cvt_pk_bf16_f32 v153, v82, v83
  v_cvt_pk_bf16_f32 v154, v84, v85
  v_cvt_pk_bf16_f32 v155, v86, v87
  v_cvt_pk_bf16_f32 v156, v88, v89
  v_cvt_pk_bf16_f32 v157, v90, v91
  v_cvt_pk_bf16_f32 v158, v92, v93
  v_cvt_pk_bf16_f32 v159, v94, v95
  ds_write_b128 v7, v[152:155] offset:4096
  ds_write_b128 v7, v[156:159] offset:5120
  s_waitcnt lgkmcnt(0)
  ds_add_u32 v4, v160
  s_cmp_lg_u32 s58, 0
  s_cbranch_scc1 LF_pd
  s_cmp_eq_u32 s42, 0
  s_cbranch_scc1 LF_pz
  s_setprio 1
  v_pk_mul_f32 v[96:97], v[96:97], v[24:25] op_sel_hi:[1,0]
  v_pk_mul_f32 v[98:99], v[98:99], v[24:25] op_sel_hi:[1,0]
  v_pk_mul_f32 v[100:101], v[100:101], v[24:25] op_sel_hi:[1,0]
  v_pk_mul_f32 v[102:103], v[102:103], v[24:25] op_sel_hi:[1,0]
  v_pk_mul_f32 v[104:105], v[104:105], v[24:25] op_sel_hi:[1,0]
  v_pk_mul_f32 v[106:107], v[106:107], v[24:25] op_sel_hi:[1,0]
  v_pk_mul_f32 v[108:109], v[108:109], v[24:25] op_sel_hi:[1,0]
  v_pk_mul_f32 v[110:111], v[110:111], v[24:25] op_sel_hi:[1,0]
  v_pk_mul_f32 v[136:137], v[96:97], v[96:97]
  v_pk_mul_f32 v[138:139], v[98:99], v[98:99]
  v_pk_mul_f32 v[140:141], v[100:101], v[100:101]
  v_pk_mul_f32 v[142:143], v[102:103], v[102:103]
  v_pk_mul_f32 v[144:145], v[104:105], v[104:105]
  v_pk_mul_f32 v[146:147], v[106:107], v[106:107]
  v_pk_mul_f32 v[148:149], v[108:109], v[108:109]
  v_pk_mul_f32 v[150:151], v[110:111], v[110:111]
  v_pk_fma_f32 v[136:137], v[136:137], v[28:29], v[28:29] op_sel:[0,0,1] op_sel_hi:[1,0,1]
  v_pk_fma_f32 v[138:139], v[138:139], v[28:29], v[28:29] op_sel:[0,0,1] op_sel_hi:[1,0,1]
  v_pk_fma_f32 v[140:141], v[140:141], v[28:29], v[28:29] op_sel:[0,0,1] op_sel_hi:[1,0,1]
  v_pk_fma_f32 v[142:143], v[142:143], v[28:29], v[28:29] op_sel:[0,0,1] op_sel_hi:[1,0,1]
  v_pk_fma_f32 v[144:145], v[144:145], v[28:29], v[28:29] op_sel:[0,0,1] op_sel_hi:[1,0,1]
  v_pk_fma_f32 v[146:147], v[146:147], v[28:29], v[28:29] op_sel:[0,0,1] op_sel_hi:[1,0,1]
  v_pk_fma_f32 v[148:149], v[148:149], v[28:29], v[28:29] op_sel:[0,0,1] op_sel_hi:[1,0,1]
  v_pk_fma_f32 v[150:151], v[150:151], v[28:29], v[28:29] op_sel:[0,0,1] op_sel_hi:[1,0,1]
  v_pk_mul_f32 v[136:137], v[136:137], v[96:97]
  v_pk_mul_f32 v[138:139], v[138:139], v[98:99]
  v_pk_mul_f32 v[140:141], v[140:141], v[100:101]
  v_pk_mul_f32 v[142:143], v[142:143], v[102:103]
  v_pk_mul_f32 v[144:145], v[144:145], v[104:105]
  v_pk_mul_f32 v[146:147], v[146:147], v[106:107]
  v_pk_mul_f32 v[148:149], v[148:149], v[108:109]
  v_pk_mul_f32 v[150:151], v[150:151], v[110:111]
  v_exp_f32 v136, v136
  v_exp_f32 v137, v137
  v_exp_f32 v138, v138
  v_exp_f32 v139, v139
  v_exp_f32 v140, v140
  v_exp_f32 v141, v141
  v_exp_f32 v142, v142
  v_exp_f32 v143, v143
  v_exp_f32 v144, v144
  v_exp_f32 v145, v145
  v_exp_f32 v146, v146
  v_exp_f32 v147, v147
  v_exp_f32 v148, v148
  v_exp_f32 v149, v149
  v_exp_f32 v150, v150
  v_exp_f32 v151, v151
  v_pk_add_f32 v[136:137], v[136:137], 1.0 op_sel_hi:[1,0]
  v_pk_add_f32 v[138:139], v[138:139], 1.0 op_sel_hi:[1,0]
  v_pk_add_f32 v[140:141], v[140:141], 1.0 op_sel_hi:[1,0]
  v_pk_add_f32 v[142:143], v[142:143], 1.0 op_sel_hi:[1,0]
  v_pk_add_f32 v[144:145], v[144:145], 1.0 op_sel_hi:[1,0]
  v_pk_add_f32 v[146:147], v[146:147], 1.0 op_sel_hi:[1,0]
  v_pk_add_f32 v[148:149], v[148:149], 1.0 op_sel_hi:[1,0]
  v_pk_add_f32 v[150:151], v[150:151], 1.0 op_sel_hi:[1,0]
  v_rcp_f32 v136, v136
  v_rcp_f32 v137, v137
  v_rcp_f32 v138, v138
  v_rcp_f32 v139, v139
  v_rcp_f32 v140, v140
  v_rcp_f32 v141, v141
  v_rcp_f32 v142, v142
  v_rcp_f32 v143, v143
  v_rcp_f32 v144, v144
  v_rcp_f32 v145, v145
  v_rcp_f32 v146, v146
  v_rcp_f32 v147, v147
  v_rcp_f32 v148, v148
  v_rcp_f32 v149, v149
  v_rcp_f32 v150, v150
  v_rcp_f32 v151, v151
  v_pk_mul_f32 v[96:97], v[96:97], v[136:137]
  v_pk_mul_f32 v[98:99], v[98:99], v[138:139]
  v_pk_mul_f32 v[100:101], v[100:101], v[140:141]
  v_pk_mul_f32 v[102:103], v[102:103], v[142:143]
  v_pk_mul_f32 v[104:105], v[104:105], v[144:145]
  v_pk_mul_f32 v[106:107], v[106:107], v[146:147]
  v_pk_mul_f32 v[108:109], v[108:109], v[148:149]
  v_pk_mul_f32 v[110:111], v[110:111], v[150:151]
  v_cvt_pk_bf16_f32 v152, v96, v97
  v_cvt_pk_bf16_f32 v153, v98, v99
  v_cvt_pk_bf16_f32 v154, v100, v101
  v_cvt_pk_bf16_f32 v155, v102, v103
  v_cvt_pk_bf16_f32 v156, v104, v105
  v_cvt_pk_bf16_f32 v157, v106, v107
  v_cvt_pk_bf16_f32 v158, v108, v109
  v_cvt_pk_bf16_f32 v159, v110, v111
  ds_write_b128 v6, v[152:155] offset:0
  ds_write_b128 v6, v[156:159] offset:1024
  v_pk_mul_f32 v[112:113], v[112:113], v[26:27] op_sel_hi:[1,0]
  v_pk_mul_f32 v[114:115], v[114:115], v[26:27] op_sel_hi:[1,0]
  v_pk_mul_f32 v[116:117], v[116:117], v[26:27] op_sel_hi:[1,0]
  v_pk_mul_f32 v[118:119], v[118:119], v[26:27] op_sel_hi:[1,0]
  v_pk_mul_f32 v[120:121], v[120:121], v[26:27] op_sel_hi:[1,0]
  v_pk_mul_f32 v[122:123], v[122:123], v[26:27] op_sel_hi:[1,0]
  v_pk_mul_f32 v[124:125], v[124:125], v[26:27] op_sel_hi:[1,0]
  v_pk_mul_f32 v[126:127], v[126:127], v[26:27] op_sel_hi:[1,0]
  v_pk_mul_f32 v[136:137], v[112:113], v[112:113]
  v_pk_mul_f32 v[138:139], v[114:115], v[114:115]
  v_pk_mul_f32 v[140:141], v[116:117], v[116:117]
  v_pk_mul_f32 v[142:143], v[118:119], v[118:119]
  v_pk_mul_f32 v[144:145], v[120:121], v[120:121]
  v_pk_mul_f32 v[146:147], v[122:123], v[122:123]
  v_pk_mul_f32 v[148:149], v[124:125], v[124:125]
  v_pk_mul_f32 v[150:151], v[126:127], v[126:127]
  v_pk_fma_f32 v[136:137], v[136:137], v[28:29], v[28:29] op_sel:[0,0,1] op_sel_hi:[1,0,1]
  v_pk_fma_f32 v[138:139], v[138:139], v[28:29], v[28:29] op_sel:[0,0,1] op_sel_hi:[1,0,1]
  v_pk_fma_f32 v[140:141], v[140:141], v[28:29], v[28:29] op_sel:[0,0,1] op_sel_hi:[1,0,1]
  v_pk_fma_f32 v[142:143], v[142:143], v[28:29], v[28:29] op_sel:[0,0,1] op_sel_hi:[1,0,1]
  v_pk_fma_f32 v[144:145], v[144:145], v[28:29], v[28:29] op_sel:[0,0,1] op_sel_hi:[1,0,1]
  v_pk_fma_f32 v[146:147], v[146:147], v[28:29], v[28:29] op_sel:[0,0,1] op_sel_hi:[1,0,1]
  v_pk_fma_f32 v[148:149], v[148:149], v[28:29], v[28:29] op_sel:[0,0,1] op_sel_hi:[1,0,1]
  v_pk_fma_f32 v[150:151], v[150:151], v[28:29], v[28:29] op_sel:[0,0,1] op_sel_hi:[1,0,1]
  v_pk_mul_f32 v[136:137], v[136:137], v[112:113]
  v_pk_mul_f32 v[138:139], v[138:139], v[114:115]
  v_pk_mul_f32 v[140:141], v[140:141], v[116:117]
  v_pk_mul_f32 v[142:143], v[142:143], v[118:119]
  v_pk_mul_f32 v[144:145], v[144:145], v[120:121]
  v_pk_mul_f32 v[146:147], v[146:147], v[122:123]
  v_pk_mul_f32 v[148:149], v[148:149], v[124:125]
  v_pk_mul_f32 v[150:151], v[150:151], v[126:127]
  v_exp_f32 v136, v136
  v_exp_f32 v137, v137
  v_exp_f32 v138, v138
  v_exp_f32 v139, v139
  v_exp_f32 v140, v140
  v_exp_f32 v141, v141
  v_exp_f32 v142, v142
  v_exp_f32 v143, v143
  v_exp_f32 v144, v144
  v_exp_f32 v145, v145
  v_exp_f32 v146, v146
  v_exp_f32 v147, v147
  v_exp_f32 v148, v148
  v_exp_f32 v149, v149
  v_exp_f32 v150, v150
  v_exp_f32 v151, v151
  v_pk_add_f32 v[136:137], v[136:137], 1.0 op_sel_hi:[1,0]
  v_pk_add_f32 v[138:139], v[138:139], 1.0 op_sel_hi:[1,0]
  v_pk_add_f32 v[140:141], v[140:141], 1.0 op_sel_hi:[1,0]
  v_pk_add_f32 v[142:143], v[142:143], 1.0 op_sel_hi:[1,0]
  v_pk_add_f32 v[144:145], v[144:145], 1.0 op_sel_hi:[1,0]
  v_pk_add_f32 v[146:147], v[146:147], 1.0 op_sel_hi:[1,0]
  v_pk_add_f32 v[148:149], v[148:149], 1.0 op_sel_hi:[1,0]
  v_pk_add_f32 v[150:151], v[150:151], 1.0 op_sel_hi:[1,0]
  v_rcp_f32 v136, v136
  v_rcp_f32 v137, v137
  v_rcp_f32 v138, v138
  v_rcp_f32 v139, v139
  v_rcp_f32 v140, v140
  v_rcp_f32 v141, v141
  v_rcp_f32 v142, v142
  v_rcp_f32 v143, v143
  v_rcp_f32 v144, v144
  v_rcp_f32 v145, v145
  v_rcp_f32 v146, v146
  v_rcp_f32 v147, v147
  v_rcp_f32 v148, v148
  v_rcp_f32 v149, v149
  v_rcp_f32 v150, v150
  v_rcp_f32 v151, v151
  v_pk_mul_f32 v[112:113], v[112:113], v[136:137]
  v_pk_mul_f32 v[114:115], v[114:115], v[138:139]
  v_pk_mul_f32 v[116:117], v[116:117], v[140:141]
  v_pk_mul_f32 v[118:119], v[118:119], v[142:143]
  v_pk_mul_f32 v[120:121], v[120:121], v[144:145]
  v_pk_mul_f32 v[122:123], v[122:123], v[146:147]
  v_pk_mul_f32 v[124:125], v[124:125], v[148:149]
  v_pk_mul_f32 v[126:127], v[126:127], v[150:151]
  v_cvt_pk_bf16_f32 v152, v112, v113
  v_cvt_pk_bf16_f32 v153, v114, v115
  v_cvt_pk_bf16_f32 v154, v116, v117
  v_cvt_pk_bf16_f32 v155, v118, v119
  v_cvt_pk_bf16_f32 v156, v120, v121
  v_cvt_pk_bf16_f32 v157, v122, v123
  v_cvt_pk_bf16_f32 v158, v124, v125
  v_cvt_pk_bf16_f32 v159, v126, v127
  ds_write_b128 v6, v[152:155] offset:4096
  ds_write_b128 v6, v[156:159] offset:5120
  s_waitcnt lgkmcnt(0)
  s_branch LF_pz
LF_Pk:
  s_mov_b32 s51, s43
  s_and_b32 s51, s51, 3
  v_lshrrev_b32 v32, 5, v1
  v_bfe_u32 v33, v1, 2, 2
  v_lshl_add_u32 v32, v32, 3, v33
  v_mul_u32_u24 v32, 40, v32
  v_bfe_u32 v33, v1, 4, 1
  v_and_b32 v34, 3, v1
  v_lshl_add_u32 v33, v33, 2, v34
  v_cmp_gt_u32 vcc, 5, v33
  v_mov_b32 v35, 155648
  v_min_u32 v33, 4, v33
  v_cndmask_b32 v7, 0, 1, vcc
  v_lshl_add_u32 v32, v33, 3, v32
  s_xor_b32 s48, s51, 0
  s_mul_i32 s48, s48, 640
  s_add_u32 s48, s48, 16384
  v_add_u32 v12, s48, v32
  v_cndmask_b32 v12, v35, v12, vcc
  s_xor_b32 s48, s51, 1
  s_mul_i32 s48, s48, 640
  s_add_u32 s48, s48, 16384
  v_add_u32 v13, s48, v32
  v_cndmask_b32 v13, v35, v13, vcc
  s_xor_b32 s48, s51, 2
  s_mul_i32 s48, s48, 640
  s_add_u32 s48, s48, 16384
  v_add_u32 v14, s48, v32
  v_cndmask_b32 v14, v35, v14, vcc
  s_xor_b32 s48, s51, 3
  s_mul_i32 s48, s48, 640
  s_add_u32 s48, s48, 16384
  v_add_u32 v15, s48, v32
  v_cndmask_b32 v15, v35, v15, vcc
  s_barrier
  ds_read_b128 v[32:35], v8 offset:0
  ds_read_b64_tr_b16 v[40:41], v12 offset:0
  ds_read_b64_tr_b16 v[42:43], v12 offset:160
  ds_read_b128 v[48:51], v9 offset:0
  ds_read_b64_tr_b16 v[56:57], v13 offset:0
  ds_read_b64_tr_b16 v[58:59], v13 offset:160
  s_mov_b32 s46, 0
.p2align 6
LF_loopk:
  s_add_u32 s46, s46, 1
  s_and_b32 s48, s46, 3
  s_cselect_b32 s48, s49, s50
  s_waitcnt lgkmcnt(3)
  v_mfma_f32_32x32x16_bf16 v[64:79], v[40:43], v[32:35], v[64:79]
  ds_read_b128 v[136:139], v10 offset:0
  ds_read_b64_tr_b16 v[144:145], v14 offset:0
  ds_read_b64_tr_b16 v[146:147], v14 offset:160
  v_mfma_f32_16x16x32_bf16 v[128:131], v[40:43], v[16:19], v[128:131]
  v_add_u32 v8, s48, v8
  v_mad_i32_i24 v12, v7, s48, v12
  v_add_u32 v9, s48, v9
  v_mad_i32_i24 v13, v7, s48, v13
  s_waitcnt lgkmcnt(3)
  v_mfma_f32_32x32x16_bf16 v[64:79], v[56:59], v[48:51], v[64:79]
  ds_read_b128 v[152:155], v11 offset:0
  ds_read_b64_tr_b16 v[160:161], v15 offset:0
  ds_read_b64_tr_b16 v[162:163], v15 offset:160
  v_add_u32 v10, s48, v10
  v_mad_i32_i24 v14, v7, s48, v14
  v_add_u32 v11, s48, v11
  v_mad_i32_i24 v15, v7, s48, v15
  s_waitcnt lgkmcnt(0)
  s_barrier
  v_mfma_f32_32x32x16_bf16 v[64:79], v[144:147], v[136:139], v[64:79]
  ds_read_b128 v[32:35], v8 offset:0
  ds_read_b64_tr_b16 v[40:41], v12 offset:0
  ds_read_b64_tr_b16 v[42:43], v12 offset:160
  v_mfma_f32_32x32x16_bf16 v[64:79], v[160:163], v[152:155], v[64:79]
  ds_read_b128 v[48:51], v9 offset:0
  ds_read_b64_tr_b16 v[56:57], v13 offset:0
  ds_read_b64_tr_b16 v[58:59], v13 offset:160
  s_cmp_lt_u32 s46, 10
  s_cbranch_scc1 LF_loopk
  s_waitcnt lgkmcnt(0)
  s_setprio 3
  v_and_b32 v166, 0xf8, v3
  s_lshl_b32 s48, s43, 8
  s_add_u32 s48, s48, 154624
  v_add_u32 v166, s48, v166
  ds_read_b64 v[24:25], v166
  v_mov_b32 v166, 160256
  ds_read_b64 v[30:31], v166
  v_and_b32 v136, 1, v1
  v_lshlrev_b32 v136, 8, v136
  v_lshrrev_b32 v137, 4, v1
  v_lshl_add_u32 v136, v137, 6, v136
  s_lshl2_add_u32 s48, s43, s59
  v_add_u32 v136, s48, v136
  v_cvt_pk_bf16_f32 v138, v128, v128
  v_cvt_pk_bf16_f32 v139, v129, v129
  v_cvt_pk_bf16_f32 v140, v130, v130
  v_cvt_pk_bf16_f32 v141, v131, v131
  v_lshlrev_b32 v138, 16, v138
  v_lshlrev_b32 v139, 16, v139
  v_lshlrev_b32 v140, 16, v140
  v_lshlrev_b32 v141, 16, v141
  v_sub_f32 v138, v128, v138
  v_sub_f32 v139, v129, v139
  v_sub_f32 v140, v130, v140
  v_sub_f32 v141, v131, v141
  v_cvt_pk_bf16_f32 v138, v128, v138
  v_cvt_pk_bf16_f32 v139, v129, v139
  v_cvt_pk_bf16_f32 v140, v130, v140
  v_cvt_pk_bf16_f32 v141, v131, v141
  s_mov_b32 exec_lo, 0x00030003
  s_mov_b32 exec_hi, 0x00030003
  ds_write_b32 v136, v138 offset:0
  ds_write_b32 v136, v139 offset:16
  ds_write_b32 v136, v140 offset:32
  ds_write_b32 v136, v141 offset:48
  s_mov_b64 exec, -1
  v_and_b32 v136, 0x1f0, v2
  v_add_u32 v136, s59, v136
  s_lshl2_add_u32 s47, s41, s43
  s_mul_i32 s50, s47, 3584
  s_add_u32 s50, s50, 9830400
  s_lshl3_add_u32 s14, s47, 18923520
  v_and_b32 v137, 31, v1
  v_lshlrev_b32 v137, 6, v137
  v_lshrrev_b32 v138, 5, v1
  v_lshl_add_u32 v137, v138, 3, v137
  s_lshl_b32 s49, s43, 11
  s_add_u32 s49, s49, 73728
  v_add_u32 v137, s49, v137
  v_bfe_u32 v139, v1, 2, 2
  v_lshl_add_u32 v139, v138, 2, v139
  v_lshlrev_b32 v139, 6, v139
  v_bfe_u32 v140, v1, 4, 1
  v_lshl_add_u32 v139, v140, 5, v139
  v_and_b32 v140, 3, v1
  v_lshl_add_u32 v139, v140, 3, v139
  v_add_u32 v139, s49, v139
  s_waitcnt lgkmcnt(0)
  s_barrier
  ds_read_b128 v[32:35], v136
  v_cndmask_b32 v20, v24, 0, s[52:53]
  v_mov_b32 v141, 0x3f803f80
  v_mov_b32 v21, v20
  v_mov_b32 v22, v20
  v_mov_b32 v23, v20
  v_mov_b32 v142, 0x00003f80
  s_waitcnt lgkmcnt(0)
  v_mfma_f32_32x32x16_bf16 v[64:79], v[32:35], v[20:23], v[64:79]
  v_lshrrev_b32 v143, 2, v1
  v_lshlrev_b32 v143, 16, v143
  v_lshl_add_u32 v143, v140, 10, v143
  v_mov_b32 v158, 0
  v_mov_b32 v159, 0
  s_nop 6
  v_mul_f32 v64, v64, v25
  v_mul_f32 v65, v65, v25
  v_mul_f32 v66, v66, v25
  v_mul_f32 v67, v67, v25
  v_mul_f32 v68, v68, v25
  v_mul_f32 v69, v69, v25
  v_mul_f32 v70, v70, v25
  v_mul_f32 v71, v71, v25
  v_mul_f32 v72, v72, v25
  v_mul_f32 v73, v73, v25
  v_mul_f32 v74, v74, v25
  v_mul_f32 v75, v75, v25
  v_cvt_pk_bf16_f32 v152, v64, v65
  v_cvt_pk_bf16_f32 v153, v66, v67
  v_cvt_pk_bf16_f32 v154, v68, v69
  v_cvt_pk_bf16_f32 v155, v70, v71
  v_cvt_pk_bf16_f32 v156, v72, v73
  v_cvt_pk_bf16_f32 v157, v74, v75
  s_cmp_eq_u32 s42, 15
  s_cbranch_scc1 LF_pv
  v_cndmask_b32 v156, v156, v141, s[52:53]
  v_cndmask_b32 v157, v157, v142, s[52:53]
  buffer_store_dwordx4 v[152:155], v2, s[36:39], s50 offen sc0 sc1
  buffer_store_dwordx2 v[156:157], v3, s[36:39], s50 offen offset:3072 sc0 sc1
  s_branch LF_pf
LF_pv:
  s_add_u32 s14, s14, 512
  s_add_u32 s50, s50, 1024
  v_cndmask_b32 v156, v156, v142, s[52:53]
  v_cndmask_b32 v157, v157, 0, s[52:53]
  ds_write_b64 v137, v[152:153] offset:0
  ds_write_b64 v137, v[154:155] offset:16
  ds_write_b64 v137, v[156:157] offset:32
  ds_write_b64 v137, v[158:159] offset:48
  s_waitcnt lgkmcnt(0)
  ds_read_b64_tr_b16 v[152:153], v139 offset:0
  ds_read_b64_tr_b16 v[154:155], v139 offset:512
  ds_read_b64_tr_b16 v[156:157], v139 offset:1024
  ds_read_b64_tr_b16 v[158:159], v139 offset:1536
  s_waitcnt lgkmcnt(0)
  buffer_store_dwordx4 v[152:155], v2, s[36:39], s50 offen sc0 sc1
  buffer_store_dwordx4 v[156:159], v2, s[36:39], s50 offen offset:1024 sc0 sc1
  s_nop 1
LF_pf:
  s_waitcnt vmcnt(0)
  s_mov_b64 exec, 0xf
  buffer_store_dwordx2 v[30:31], v143, s[36:39], s14 offen sc0 sc1
  s_mov_b64 exec, 0xf0
  buffer_store_dwordx2 v[30:31], v143, s[36:39], s14 offen sc0 sc1
  s_mov_b64 exec, -1
LF_pz:
  v_mov_b32 v160, 2
  ds_write_b32 v4, v160
LF_pd:
  s_branch LF_att
LF_S:
  s_mov_b32 s51, s43
  s_and_b32 s51, s51, 3
  v_lshrrev_b32 v32, 5, v1
  v_bfe_u32 v33, v1, 2, 2
  v_lshl_add_u32 v32, v32, 3, v33
  v_mul_u32_u24 v32, 80, v32
  v_bfe_u32 v33, v1, 4, 1
  v_and_b32 v34, 3, v1
  v_lshl_add_u32 v33, v33, 2, v34
  v_cmp_gt_u32 vcc, 5, v33
  v_mov_b32 v35, 155648
  v_min_u32 v33, 4, v33
  v_cndmask_b32 v7, 0, 1, vcc
  v_lshl_add_u32 v32, v33, 3, v32
  s_xor_b32 s48, s51, 0
  s_mul_i32 s48, s48, 1280
  s_add_u32 s48, s48, 32768
  v_add_u32 v12, s48, v32
  v_cndmask_b32 v12, v35, v12, vcc
  s_xor_b32 s48, s51, 1
  s_mul_i32 s48, s48, 1280
  s_add_u32 s48, s48, 32768
  v_add_u32 v13, s48, v32
  v_cndmask_b32 v13, v35, v13, vcc
  s_xor_b32 s48, s51, 2
  s_mul_i32 s48, s48, 1280
  s_add_u32 s48, s48, 32768
  v_add_u32 v14, s48, v32
  v_cndmask_b32 v14, v35, v14, vcc
  s_xor_b32 s48, s51, 3
  s_mul_i32 s48, s48, 1280
  s_add_u32 s48, s48, 32768
  v_add_u32 v15, s48, v32
  v_cndmask_b32 v15, v35, v15, vcc
  s_setprio 1
  s_barrier
  ds_read_b128 v[32:35], v8 offset:0
  ds_read_b64_tr_b16 v[40:41], v12 offset:0
  ds_read_b64_tr_b16 v[42:43], v12 offset:320
  ds_read_b64_tr_b16 v[44:45], v12 offset:40
  ds_read_b64_tr_b16 v[46:47], v12 offset:360
  ds_read_b128 v[48:51], v9 offset:0
  ds_read_b64_tr_b16 v[56:57], v13 offset:0
  ds_read_b64_tr_b16 v[58:59], v13 offset:320
  ds_read_b64_tr_b16 v[60:61], v13 offset:40
  ds_read_b64_tr_b16 v[62:63], v13 offset:360
  s_mov_b32 s46, 0
.p2align 6
LF_loops:
  s_add_u32 s46, s46, 1
  s_and_b32 s48, s46, 3
  s_cselect_b32 s48, s49, s50
  s_waitcnt lgkmcnt(5)
  v_mfma_f32_32x32x16_bf16 v[64:79], v[40:43], v[32:35], v[64:79]
  ds_read_b128 v[80:83], v10 offset:0
  ds_read_b64_tr_b16 v[88:89], v14 offset:0
  ds_read_b64_tr_b16 v[90:91], v14 offset:320
  v_mfma_f32_16x16x32_bf16 v[128:131], v[40:43], v[16:19], v[128:131]
  v_mfma_f32_32x32x16_bf16 v[96:111], v[44:47], v[32:35], v[96:111]
  ds_read_b64_tr_b16 v[92:93], v14 offset:40
  ds_read_b64_tr_b16 v[94:95], v14 offset:360
  v_add_u32 v8, s48, v8
  v_mfma_f32_16x16x32_bf16 v[132:135], v[44:47], v[16:19], v[132:135]
  v_mad_i32_i24 v12, v7, s48, v12
  v_add_u32 v9, s48, v9
  v_mad_i32_i24 v13, v7, s48, v13
  s_waitcnt lgkmcnt(5)
  v_mfma_f32_32x32x16_bf16 v[64:79], v[56:59], v[48:51], v[64:79]
  ds_read_b128 v[112:115], v11 offset:0
  ds_read_b64_tr_b16 v[120:121], v15 offset:0
  ds_read_b64_tr_b16 v[122:123], v15 offset:320
  v_mfma_f32_32x32x16_bf16 v[96:111], v[60:63], v[48:51], v[96:111]
  ds_read_b64_tr_b16 v[124:125], v15 offset:40
  ds_read_b64_tr_b16 v[126:127], v15 offset:360
  v_add_u32 v10, s48, v10
  v_mad_i32_i24 v14, v7, s48, v14
  v_add_u32 v11, s48, v11
  v_mad_i32_i24 v15, v7, s48, v15
  s_waitcnt lgkmcnt(0)
  s_barrier
  v_mfma_f32_32x32x16_bf16 v[64:79], v[88:91], v[80:83], v[64:79]
  ds_read_b128 v[32:35], v8 offset:0
  ds_read_b64_tr_b16 v[40:41], v12 offset:0
  ds_read_b64_tr_b16 v[42:43], v12 offset:320
  v_mfma_f32_32x32x16_bf16 v[96:111], v[92:95], v[80:83], v[96:111]
  ds_read_b64_tr_b16 v[44:45], v12 offset:40
  ds_read_b64_tr_b16 v[46:47], v12 offset:360
  v_mfma_f32_32x32x16_bf16 v[64:79], v[120:123], v[112:115], v[64:79]
  ds_read_b128 v[48:51], v9 offset:0
  ds_read_b64_tr_b16 v[56:57], v13 offset:0
  ds_read_b64_tr_b16 v[58:59], v13 offset:320
  v_mfma_f32_32x32x16_bf16 v[96:111], v[124:127], v[112:115], v[96:111]
  ds_read_b64_tr_b16 v[60:61], v13 offset:40
  ds_read_b64_tr_b16 v[62:63], v13 offset:360
  s_cmp_lt_u32 s46, 10
  s_cbranch_scc1 LF_loops
  s_waitcnt lgkmcnt(0)
  s_setprio 3
  v_and_b32 v166, 0xf8, v3
  s_lshl_b32 s48, s43, 8
  s_add_u32 s48, s48, 154624
  v_add_u32 v166, s48, v166
  ds_read_b64 v[152:153], v166
  v_mov_b32 v166, 160256
  ds_read_b64 v[30:31], v166
  s_and_b32 s56, s2, 3
  s_lshl_b32 s56, s56, 10
  s_add_u32 s56, s56, 18923520
  s_sub_u32 s48, s42, 1
  s_cmp_lt_u32 s48, 13
  s_cselect_b32 s57, 0, 65536
  s_add_u32 s56, s56, s57
  v_and_b32 v136, 1, v1
  v_lshlrev_b32 v136, 8, v136
  v_lshrrev_b32 v137, 4, v1
  v_lshl_add_u32 v136, v137, 6, v136
  s_lshl2_add_u32 s48, s43, s59
  v_add_u32 v136, s48, v136
  v_cvt_pk_bf16_f32 v138, v128, v128
  v_cvt_pk_bf16_f32 v139, v129, v129
  v_cvt_pk_bf16_f32 v140, v130, v130
  v_cvt_pk_bf16_f32 v141, v131, v131
  v_cvt_pk_bf16_f32 v142, v132, v132
  v_cvt_pk_bf16_f32 v143, v133, v133
  v_cvt_pk_bf16_f32 v144, v134, v134
  v_cvt_pk_bf16_f32 v145, v135, v135
  v_lshlrev_b32 v138, 16, v138
  v_lshlrev_b32 v139, 16, v139
  v_lshlrev_b32 v140, 16, v140
  v_lshlrev_b32 v141, 16, v141
  v_lshlrev_b32 v142, 16, v142
  v_lshlrev_b32 v143, 16, v143
  v_lshlrev_b32 v144, 16, v144
  v_lshlrev_b32 v145, 16, v145
  v_sub_f32 v138, v128, v138
  v_sub_f32 v139, v129, v139
  v_sub_f32 v140, v130, v140
  v_sub_f32 v141, v131, v141
  v_sub_f32 v142, v132, v142
  v_sub_f32 v143, v133, v143
  v_sub_f32 v144, v134, v144
  v_sub_f32 v145, v135, v145
  v_cvt_pk_bf16_f32 v138, v128, v138
  v_cvt_pk_bf16_f32 v139, v129, v139
  v_cvt_pk_bf16_f32 v140, v130, v140
  v_cvt_pk_bf16_f32 v141, v131, v141
  v_cvt_pk_bf16_f32 v142, v132, v142
  v_cvt_pk_bf16_f32 v143, v133, v143
  v_cvt_pk_bf16_f32 v144, v134, v144
  v_cvt_pk_bf16_f32 v145, v135, v145
  s_mov_b32 exec_lo, 0x00030003
  s_mov_b32 exec_hi, 0x00030003
  ds_write_b32 v136, v138 offset:0
  ds_write_b32 v136, v139 offset:16
  ds_write_b32 v136, v140 offset:32
  ds_write_b32 v136, v141 offset:48
  ds_write_b32 v136, v142 offset:512
  ds_write_b32 v136, v143 offset:528
  ds_write_b32 v136, v144 offset:544
  ds_write_b32 v136, v145 offset:560
  s_mov_b64 exec, -1
  v_and_b32 v136, 0x1f0, v2
  v_add_u32 v136, s59, v136
  s_waitcnt lgkmcnt(0)
  s_barrier
  ds_read_b128 v[32:35], v136 offset:0
  ds_read_b128 v[36:39], v136 offset:512
  v_mov_b32 v80, 0
  v_mov_b32 v81, 0
  s_or_b32 s48, s57, s43
  s_cbranch_scc1 LF_kv0
  buffer_load_dwordx4 v[80:83], v2, s[36:39], s56 offen sc0 sc1
LF_kv0:
  s_cmp_lg_u32 s43, 0
  s_cbranch_scc1 LF_kv4
  s_waitcnt vmcnt(0)
  v_cmp_ne_u64 vcc, v[80:81], v[30:31]
  v_cmp_ne_u64 s[54:55], v[82:83], v[30:31]
  s_nop 0
  s_or_b64 vcc, vcc, s[54:55]
  s_cbranch_vccz LF_kv1
  s_cmp_eq_u32 s57, 0
  s_cbranch_scc1 LF_kv3
  s_sleep 40
LF_kv3:
  s_mov_b32 s48, 0x20000
LF_pl5:
  buffer_load_dwordx4 v[80:83], v2, s[36:39], s56 offen sc0 sc1
  s_waitcnt vmcnt(0)
  v_cmp_ne_u64 vcc, v[80:81], v[30:31]
  s_nop 0
  v_cmp_ne_u64 s[54:55], v[82:83], v[30:31]
  s_nop 0
  s_or_b64 vcc, vcc, s[54:55]
  s_cbranch_vccz LF_pl5d
  s_sleep 8
  s_sub_u32 s48, s48, 1
  s_cbranch_scc0 LF_pl5
LF_pl5d:
LF_kv1:
  s_mov_b32 s49, 9830400
  s_mov_b32 m0, 135168
  s_nop 0
  buffer_load_dwordx4 v2, s[36:39], s49 offen sc1 lds
  s_mov_b32 m0, 136192
  s_nop 0
  buffer_load_dwordx4 v2, s[36:39], s49 offen offset:3072 sc1 lds
  s_add_u32 s49, s49, 3584
  s_mov_b32 m0, 136192
  s_nop 0
  buffer_load_dwordx4 v2, s[36:39], s49 offen sc1 lds
  s_mov_b32 m0, 137216
  s_nop 0
  buffer_load_dwordx4 v2, s[36:39], s49 offen offset:3072 sc1 lds
  s_add_u32 s49, s49, 3584
  s_mov_b32 m0, 137216
  s_nop 0
  buffer_load_dwordx4 v2, s[36:39], s49 offen sc1 lds
  s_mov_b32 m0, 138240
  s_nop 0
  buffer_load_dwordx4 v2, s[36:39], s49 offen offset:3072 sc1 lds
  s_add_u32 s49, s49, 3584
  s_mov_b32 m0, 138240
  s_nop 0
  buffer_load_dwordx4 v2, s[36:39], s49 offen sc1 lds
  s_mov_b32 m0, 139264
  s_nop 0
  buffer_load_dwordx4 v2, s[36:39], s49 offen offset:3072 sc1 lds
  s_add_u32 s49, s49, 3584
LF_kv4:
  v_cndmask_b32 v20, v152, 0, s[52:53]
  v_mul_f32 v24, 0x3ea52b5c, v153
  v_mov_b32 v21, v20
  v_mov_b32 v22, v20
  v_mov_b32 v23, v20
  v_mov_b32 v137, 160320
  v_add_u32 v138, 135168, v2
  v_add_u32 v139, 139264, v3
  s_waitcnt lgkmcnt(0)
  v_mfma_f32_32x32x16_bf16 v[64:79], v[32:35], v[20:23], v[64:79]
  v_mfma_f32_32x32x16_bf16 v[96:111], v[36:39], v[20:23], v[96:111]
  s_mul_i32 s48, s43, 1536
  s_add_u32 s48, s48, 122880
  v_add_u32 v141, s48, v2
  v_add_u32 v142, s48, v3
  s_nop 7
  v_mul_f32 v64, v64, v24
  v_mul_f32 v65, v65, v24
  v_mul_f32 v66, v66, v24
  v_mul_f32 v67, v67, v24
  v_mul_f32 v68, v68, v24
  v_mul_f32 v69, v69, v24
  v_mul_f32 v70, v70, v24
  v_mul_f32 v71, v71, v24
  v_mul_f32 v72, v72, v24
  v_mul_f32 v73, v73, v24
  v_mul_f32 v74, v74, v24
  v_mul_f32 v75, v75, v24
  v_cvt_pk_bf16_f32 v152, v64, v65
  v_cvt_pk_bf16_f32 v153, v66, v67
  v_cvt_pk_bf16_f32 v154, v68, v69
  v_cvt_pk_bf16_f32 v155, v70, v71
  v_cvt_pk_bf16_f32 v156, v72, v73
  v_cvt_pk_bf16_f32 v157, v74, v75
  v_cndmask_b32 v156, v156, 0, s[52:53]
  v_cndmask_b32 v157, v157, 0, s[52:53]
  v_mul_f32 v96, v96, v24
  v_mul_f32 v97, v97, v24
  v_mul_f32 v98, v98, v24
  v_mul_f32 v99, v99, v24
  v_mul_f32 v100, v100, v24
  v_mul_f32 v101, v101, v24
  v_mul_f32 v102, v102, v24
  v_mul_f32 v103, v103, v24
  v_mul_f32 v104, v104, v24
  v_mul_f32 v105, v105, v24
  v_mul_f32 v106, v106, v24
  v_mul_f32 v107, v107, v24
  v_cvt_pk_bf16_f32 v158, v96, v97
  v_cvt_pk_bf16_f32 v159, v98, v99
  v_cvt_pk_bf16_f32 v160, v100, v101
  v_cvt_pk_bf16_f32 v161, v102, v103
  v_cvt_pk_bf16_f32 v162, v104, v105
  v_cvt_pk_bf16_f32 v163, v106, v107
  v_cndmask_b32 v162, v162, 0, s[52:53]
  v_cndmask_b32 v163, v163, 0, s[52:53]
  s_cmp_lg_u32 s43, 0
  s_cbranch_scc1 LF_kv2
  v_mov_b32 v80, 1
  s_waitcnt vmcnt(0)
  ds_write_b32 v137, v80
LF_kv2:
  s_setprio 1
LF_sp6:
  ds_read_b32 v143, v137
  s_waitcnt lgkmcnt(0)
  v_cmp_gt_u32 vcc, 1, v143
  s_nop 0
  s_cbranch_vccz LF_sp6d
  s_sleep 1
  s_branch LF_sp6
LF_sp6d:
  s_setprio 3
  ds_read_b128 v[32:35], v138 offset:0
  ds_read_b64 v[36:37], v139 offset:0
  ds_read_b128 v[40:43], v138 offset:1024
  ds_read_b64 v[44:45], v139 offset:1024
  ds_read_b128 v[48:51], v138 offset:2048
  ds_read_b64 v[52:53], v139 offset:2048
  ds_read_b128 v[56:59], v138 offset:3072
  ds_read_b64 v[60:61], v139 offset:3072
  s_waitcnt lgkmcnt(6)
  v_mfma_f32_32x32x16_bf16 v[64:79], v[32:35], v[152:155], 0
  v_mfma_f32_32x32x8bf16_1k v[64:79], v[36:37], v[156:157], v[64:79]
  v_mfma_f32_32x32x16_bf16 v[80:95], v[32:35], v[158:161], 0
  v_mfma_f32_32x32x8bf16_1k v[80:95], v[36:37], v[162:163], v[80:95]
  s_waitcnt lgkmcnt(4)
  v_mfma_f32_32x32x16_bf16 v[96:111], v[40:43], v[152:155], 0
  v_mfma_f32_32x32x8bf16_1k v[96:111], v[44:45], v[156:157], v[96:111]
  s_nop 6
  v_max3_f32 v144, v64, v65, v66
  v_max_f32 v144, v144, v67
  v_max3_f32 v144, v144, v68, v69
  v_max3_f32 v144, v144, v70, v71
  v_max3_f32 v144, v144, v72, v73
  v_max3_f32 v144, v144, v74, v75
  v_max3_f32 v144, v144, v76, v77
  v_max3_f32 v144, v144, v78, v79
  v_mfma_f32_32x32x16_bf16 v[112:127], v[40:43], v[158:161], 0
  v_mfma_f32_32x32x8bf16_1k v[112:127], v[44:45], v[162:163], v[112:127]
  v_max3_f32 v145, v80, v81, v82
  v_max_f32 v145, v145, v83
  v_max3_f32 v145, v145, v84, v85
  v_max3_f32 v145, v145, v86, v87
  v_max3_f32 v145, v145, v88, v89
  v_max3_f32 v145, v145, v90, v91
  v_max3_f32 v145, v145, v92, v93
  v_max3_f32 v145, v145, v94, v95
  s_waitcnt lgkmcnt(2)
  v_mfma_f32_32x32x16_bf16 v[64:79], v[48:51], v[152:155], 0
  v_mfma_f32_32x32x8bf16_1k v[64:79], v[52:53], v[156:157], v[64:79]
  v_max3_f32 v144, v144, v96, v97
  v_max3_f32 v144, v144, v98, v99
  v_max3_f32 v144, v144, v100, v101
  v_max3_f32 v144, v144, v102, v103
  v_max3_f32 v144, v144, v104, v105
  v_max3_f32 v144, v144, v106, v107
  v_max3_f32 v144, v144, v108, v109
  v_max3_f32 v144, v144, v110, v111
  v_mfma_f32_32x32x16_bf16 v[80:95], v[48:51], v[158:161], 0
  v_mfma_f32_32x32x8bf16_1k v[80:95], v[52:53], v[162:163], v[80:95]
  v_max3_f32 v145, v145, v112, v113
  v_max3_f32 v145, v145, v114, v115
  v_max3_f32 v145, v145, v116, v117
  v_max3_f32 v145, v145, v118, v119
  v_max3_f32 v145, v145, v120, v121
  v_max3_f32 v145, v145, v122, v123
  v_max3_f32 v145, v145, v124, v125
  v_max3_f32 v145, v145, v126, v127
  s_waitcnt lgkmcnt(0)
  v_mfma_f32_32x32x16_bf16 v[96:111], v[56:59], v[152:155], 0
  v_mfma_f32_32x32x8bf16_1k v[96:111], v[60:61], v[156:157], v[96:111]
  v_max3_f32 v144, v144, v64, v65
  v_max3_f32 v144, v144, v66, v67
  v_max3_f32 v144, v144, v68, v69
  v_max3_f32 v144, v144, v70, v71
  v_max3_f32 v144, v144, v72, v73
  v_max3_f32 v144, v144, v74, v75
  v_max3_f32 v144, v144, v76, v77
  v_max3_f32 v144, v144, v78, v79
  v_mfma_f32_32x32x16_bf16 v[112:127], v[56:59], v[158:161], 0
  v_mfma_f32_32x32x8bf16_1k v[112:127], v[60:61], v[162:163], v[112:127]
  v_max3_f32 v145, v145, v80, v81
  v_max3_f32 v145, v145, v82, v83
  v_max3_f32 v145, v145, v84, v85
  v_max3_f32 v145, v145, v86, v87
  v_max3_f32 v145, v145, v88, v89
  v_max3_f32 v145, v145, v90, v91
  v_max3_f32 v145, v145, v92, v93
  v_max3_f32 v145, v145, v94, v95
  s_nop 1
  v_max3_f32 v144, v144, v96, v97
  v_max3_f32 v144, v144, v98, v99
  v_max3_f32 v144, v144, v100, v101
  v_max3_f32 v144, v144, v102, v103
  v_max3_f32 v144, v144, v104, v105
  v_max3_f32 v144, v144, v106, v107
  v_max3_f32 v144, v144, v108, v109
  v_max3_f32 v144, v144, v110, v111
  v_max3_f32 v145, v145, v112, v113
  v_max3_f32 v145, v145, v114, v115
  v_max3_f32 v145, v145, v116, v117
  v_max3_f32 v145, v145, v118, v119
  v_max3_f32 v145, v145, v120, v121
  v_max3_f32 v145, v145, v122, v123
  v_max3_f32 v145, v145, v124, v125
  v_max3_f32 v145, v145, v126, v127
  v_mov_b32 v146, v144
  s_nop 1
  v_permlane32_swap_b32 v146, v144
  s_nop 0
  v_max_f32 v144, v144, v146
  v_add_f32 v144, 0x42c00000, v144
  v_cvt_pk_bf16_f32 v146, -v144, -v144
  v_lshlrev_b32 v146, 16, v146
  v_add_f32 v147, v144, v146
  v_cvt_pk_bf16_f32 v148, v146, -v147
  v_and_b32 v146, 0xffff0000, v148
  v_add_f32 v147, v147, v146
  v_cvt_pk_bf16_f32 v149, -v147, 0
  v_cndmask_b32 v156, v156, v148, s[52:53]
  v_cndmask_b32 v157, v157, v149, s[52:53]
  ds_write_b128 v141, v[152:155] offset:0
  ds_write_b64 v142, v[156:157] offset:1024
  v_mov_b32 v146, v145
  s_nop 1
  v_permlane32_swap_b32 v146, v145
  s_nop 0
  v_max_f32 v145, v145, v146
  v_add_f32 v145, 0x42c00000, v145
  v_cvt_pk_bf16_f32 v146, -v145, -v145
  v_lshlrev_b32 v146, 16, v146
  v_add_f32 v147, v145, v146
  v_cvt_pk_bf16_f32 v148, v146, -v147
  v_and_b32 v146, 0xffff0000, v148
  v_add_f32 v147, v147, v146
  v_cvt_pk_bf16_f32 v149, -v147, 0
  v_cndmask_b32 v162, v162, v148, s[52:53]
  v_cndmask_b32 v163, v163, v149, s[52:53]
  ds_write_b128 v141, v[158:161] offset:6144
  ds_write_b64 v142, v[162:163] offset:7168
  v_mov_b32 v136, 3
  s_waitcnt lgkmcnt(0)
  ds_write_b32 v4, v136
LF_att:
  v_mov_b32 v36, v4
  s_and_b32 s63, s40, 3
  s_lshl2_add_u32 s47, s41, s63
  s_mul_i32 s61, s63, 3584
  s_add_u32 s61, s61, 9830400
  s_add_u32 s60, s61, 14336
  s_mul_i32 s48, s40, 1536
  s_add_u32 s48, s48, 122880
  v_add_u32 v24, s48, v2
  v_add_u32 v25, s48, v3
  s_xor_b32 s48, s40, 1
  s_mul_i32 s48, s48, 1536
  s_add_u32 s48, s48, 122880
  v_add_u32 v26, s48, v2
  v_add_u32 v27, s48, v3
  s_xor_b32 s48, s40, 2
  s_mul_i32 s48, s48, 1536
  s_add_u32 s48, s48, 122880
  v_add_u32 v28, s48, v2
  v_add_u32 v29, s48, v3
  s_xor_b32 s48, s40, 3
  s_mul_i32 s48, s48, 1536
  s_add_u32 s48, s48, 122880
  v_add_u32 v30, s48, v2
  v_add_u32 v31, s48, v3
  s_lshl_b32 s48, s63, 10
  s_add_u32 s48, s48, 135168
  v_add_u32 v32, s48, v2
  v_add_u32 v33, s48, v3
  v_and_b32 v34, 3, v1
  v_lshlrev_b32 v34, 8, v34
  v_add_u32 v34, 162816, v34
  v_mov_b32 v35, 5
  v_mov_b32 v104, 0
  v_mov_b32 v105, 0
  v_mov_b32 v106, 0
  v_mov_b32 v107, 0
  v_mov_b32 v108, 0
  v_mov_b32 v109, 0
  v_mov_b32 v110, 0
  v_mov_b32 v111, 0
  v_mov_b32 v112, 0
  v_mov_b32 v113, 0
  v_mov_b32 v114, 0
  v_mov_b32 v115, 0
  v_mov_b32 v116, 0
  v_mov_b32 v117, 0
  v_mov_b32 v118, 0
  v_mov_b32 v119, 0
LF_sp7:
  ds_read_b32 v8, v34
  s_waitcnt lgkmcnt(0)
  v_cmp_gt_u32 vcc, 3, v8
  s_nop 0
  s_cbranch_vccz LF_sp7d
  s_sleep 1
  s_branch LF_sp7
LF_sp7d:
  s_setprio 3
  ds_read_b128 v[144:147], v32
  ds_read_b64 v[4:5], v33 offset:4096
  ds_read_b128 v[120:123], v24
  ds_read_b64 v[136:137], v25 offset:1024
  ds_read_b128 v[124:127], v26
  ds_read_b64 v[138:139], v27 offset:1024
  ds_read_b128 v[128:131], v28
  ds_read_b64 v[140:141], v29 offset:1024
  ds_read_b128 v[132:135], v30
  ds_read_b64 v[142:143], v31 offset:1024
  buffer_load_dwordx4 v[152:155], v2, s[36:39], s61 offen offset:1024 sc1
  buffer_load_dwordx4 v[156:159], v2, s[36:39], s61 offen offset:2048 sc1
  s_add_u32 s61, s61, 14336
  s_min_u32 s61, s61, 10056192
  buffer_load_dwordx4 v[148:151], v2, s[36:39], s60 offen sc1
  buffer_load_dwordx2 v[6:7], v3, s[36:39], s60 offen offset:3072 sc1
  s_add_u32 s60, s60, 14336
  s_min_u32 s60, s60, 10056192
  s_mov_b32 s22, 0x00ffffff
  s_mov_b32 s23, 0x00ffffff
  s_mov_b32 s24, 0x07060302
  s_waitcnt lgkmcnt(6)
  v_mfma_f32_32x32x16_bf16 v[8:23], v[144:147], v[120:123], 0
  v_mfma_f32_32x32x8bf16_1k v[8:23], v[4:5], v[136:137], v[8:23]
  s_waitcnt lgkmcnt(0)
  ds_write_b32 v36, v35
  s_nop 6
  s_mov_b32 s46, 8
  s_setprio 2
  v_mfma_f32_32x32x16_bf16 v[24:39], v[144:147], v[124:127], 0
  v_exp_f32 v8, v8
  v_exp_f32 v9, v9
  v_exp_f32 v10, v10
  v_exp_f32 v11, v11
  v_exp_f32 v12, v12
  v_cvt_pk_bf16_f32 v40, v8, v9
  v_mfma_f32_32x32x8bf16_1k v[24:39], v[4:5], v[138:139], v[24:39]
  v_exp_f32 v13, v13
  v_exp_f32 v14, v14
  v_cvt_pk_bf16_f32 v41, v10, v11
  v_exp_f32 v15, v15
  v_exp_f32 v16, v16
  v_cvt_pk_bf16_f32 v42, v12, v13
  s_nop 0
  v_exp_f32 v17, v17
  v_cvt_pk_bf16_f32 v43, v14, v15
  v_exp_f32 v18, v18
  v_exp_f32 v19, v19
  v_cvt_pk_bf16_f32 v44, v16, v17
  v_exp_f32 v20, v20
  s_nop 0
  v_exp_f32 v21, v21
  v_cvt_pk_bf16_f32 v45, v18, v19
  v_exp_f32 v22, v22
  v_exp_f32 v23, v23
  v_cvt_pk_bf16_f32 v46, v20, v21
  v_cvt_pk_bf16_f32 v47, v22, v23
  v_mfma_f32_32x32x16_bf16 v[8:23], v[144:147], v[128:131], 0
  v_exp_f32 v24, v24
  v_exp_f32 v25, v25
  v_exp_f32 v26, v26
  v_exp_f32 v27, v27
  v_exp_f32 v28, v28
  v_cvt_pk_bf16_f32 v48, v24, v25
  v_mfma_f32_32x32x8bf16_1k v[8:23], v[4:5], v[140:141], v[8:23]
  v_exp_f32 v29, v29
  v_exp_f32 v30, v30
  v_cvt_pk_bf16_f32 v49, v26, v27
  v_exp_f32 v31, v31
  v_exp_f32 v32, v32
  v_cvt_pk_bf16_f32 v50, v28, v29
  s_waitcnt vmcnt(2)
  v_mfma_f32_32x32x16_bf16 v[56:71], v[152:155], v[40:43], 0
  v_exp_f32 v33, v33
  v_cvt_pk_bf16_f32 v51, v30, v31
  v_exp_f32 v34, v34
  v_exp_f32 v35, v35
  v_cvt_pk_bf16_f32 v52, v32, v33
  v_exp_f32 v36, v36
  v_mfma_f32_32x32x16_bf16 v[56:71], v[156:159], v[44:47], v[56:71]
  v_exp_f32 v37, v37
  buffer_load_dwordx4 v[160:163], v2, s[36:39], s61 offen offset:1024 sc1
  buffer_load_dwordx4 v[164:167], v2, s[36:39], s61 offen offset:2048 sc1
  s_add_u32 s61, s61, 14336
  s_min_u32 s61, s61, 10056192
  v_cvt_pk_bf16_f32 v53, v34, v35
  v_exp_f32 v38, v38
  v_exp_f32 v39, v39
  v_cvt_pk_bf16_f32 v54, v36, v37
  v_cvt_pk_bf16_f32 v55, v38, v39
  v_mfma_f32_32x32x16_bf16 v[24:39], v[144:147], v[132:135], 0
  v_exp_f32 v8, v8
  v_exp_f32 v9, v9
  v_exp_f32 v10, v10
  v_exp_f32 v11, v11
  v_exp_f32 v12, v12
  v_cvt_pk_bf16_f32 v40, v8, v9
  v_mfma_f32_32x32x8bf16_1k v[24:39], v[4:5], v[142:143], v[24:39]
  v_exp_f32 v13, v13
  v_exp_f32 v14, v14
  v_cvt_pk_bf16_f32 v41, v10, v11
  v_exp_f32 v15, v15
  v_exp_f32 v16, v16
  v_cvt_pk_bf16_f32 v42, v12, v13
  v_mfma_f32_32x32x16_bf16 v[72:87], v[152:155], v[48:51], 0
  v_exp_f32 v17, v17
  v_cvt_pk_bf16_f32 v43, v14, v15
  v_exp_f32 v18, v18
  v_exp_f32 v19, v19
  v_cvt_pk_bf16_f32 v44, v16, v17
  v_exp_f32 v20, v20
  v_mfma_f32_32x32x16_bf16 v[72:87], v[156:159], v[52:55], v[72:87]
  v_exp_f32 v21, v21
  v_cvt_pk_bf16_f32 v45, v18, v19
  v_exp_f32 v22, v22
  v_exp_f32 v23, v23
  v_cvt_pk_bf16_f32 v46, v20, v21
  v_cvt_pk_bf16_f32 v47, v22, v23
  s_waitcnt vmcnt(2)
  v_mfma_f32_32x32x16_bf16 v[8:23], v[148:151], v[120:123], 0
  v_exp_f32 v24, v24
  v_exp_f32 v25, v25
  v_exp_f32 v26, v26
  v_exp_f32 v27, v27
  v_exp_f32 v28, v28
  v_cvt_pk_bf16_f32 v48, v24, v25
  v_mfma_f32_32x32x8bf16_1k v[8:23], v[6:7], v[136:137], v[8:23]
  v_exp_f32 v29, v29
  v_exp_f32 v30, v30
  v_cvt_pk_bf16_f32 v49, v26, v27
  v_exp_f32 v31, v31
  v_exp_f32 v32, v32
  v_cvt_pk_bf16_f32 v50, v28, v29
  v_mfma_f32_32x32x16_bf16 v[88:103], v[152:155], v[40:43], 0
  v_exp_f32 v33, v33
  v_cvt_pk_bf16_f32 v51, v30, v31
  v_exp_f32 v34, v34
  v_exp_f32 v35, v35
  v_cvt_pk_bf16_f32 v52, v32, v33
  v_exp_f32 v36, v36
  v_mfma_f32_32x32x16_bf16 v[88:103], v[156:159], v[44:47], v[88:103]
  v_exp_f32 v37, v37
  buffer_load_dwordx4 v[144:147], v2, s[36:39], s60 offen sc1
  s_mov_b32 exec_hi, 0
  buffer_load_dwordx2 v[4:5], v3, s[36:39], s60 offen offset:3072 sc1
  s_mov_b32 exec_hi, -1
  s_add_u32 s60, s60, 14336
  s_min_u32 s60, s60, 10056192
  v_cvt_pk_bf16_f32 v53, v34, v35
  v_exp_f32 v38, v38
  v_exp_f32 v39, v39
  v_cvt_pk_bf16_f32 v54, v36, v37
  v_cvt_pk_bf16_f32 v55, v38, v39
  s_branch LF_ain
.p2align 6
LF_aloop:
  v_mfma_f32_32x32x16_bf16 v[24:39], v[144:147], v[124:127], 0
  v_exp_f32 v8, v8
  v_exp_f32 v9, v9
  v_exp_f32 v10, v10
  v_exp_f32 v11, v11
  v_exp_f32 v12, v12
  v_cvt_pk_bf16_f32 v40, v8, v9
  v_mfma_f32_32x32x8bf16_1k v[24:39], v[4:5], v[138:139], v[24:39]
  v_exp_f32 v13, v13
  v_exp_f32 v14, v14
  v_cvt_pk_bf16_f32 v41, v10, v11
  v_exp_f32 v15, v15
  v_exp_f32 v16, v16
  v_cvt_pk_bf16_f32 v42, v12, v13
  v_mfma_f32_32x32x16_bf16 v[104:119], v[160:163], v[48:51], v[104:119]
  v_exp_f32 v17, v17
  v_cvt_pk_bf16_f32 v43, v14, v15
  v_exp_f32 v18, v18
  v_exp_f32 v19, v19
  v_cvt_pk_bf16_f32 v44, v16, v17
  v_exp_f32 v20, v20
  v_mfma_f32_32x32x16_bf16 v[104:119], v[164:167], v[52:55], v[104:119]
  v_exp_f32 v21, v21
  v_cvt_pk_bf16_f32 v45, v18, v19
  v_exp_f32 v22, v22
  v_exp_f32 v23, v23
  v_cvt_pk_bf16_f32 v46, v20, v21
  v_cvt_pk_bf16_f32 v47, v22, v23
  v_mfma_f32_32x32x16_bf16 v[8:23], v[144:147], v[128:131], 0
  v_exp_f32 v24, v24
  v_exp_f32 v25, v25
  v_exp_f32 v26, v26
  v_exp_f32 v27, v27
  v_exp_f32 v28, v28
  v_cvt_pk_bf16_f32 v48, v24, v25
  v_mfma_f32_32x32x8bf16_1k v[8:23], v[4:5], v[140:141], v[8:23]
  v_exp_f32 v29, v29
  v_exp_f32 v30, v30
  v_cvt_pk_bf16_f32 v49, v26, v27
  v_exp_f32 v31, v31
  v_exp_f32 v32, v32
  v_cvt_pk_bf16_f32 v50, v28, v29
  s_waitcnt vmcnt(2)
  v_mfma_f32_32x32x16_bf16 v[56:71], v[152:155], v[40:43], v[56:71]
  v_exp_f32 v33, v33
  v_cvt_pk_bf16_f32 v51, v30, v31
  v_exp_f32 v34, v34
  v_exp_f32 v35, v35
  v_cvt_pk_bf16_f32 v52, v32, v33
  v_exp_f32 v36, v36
  v_mfma_f32_32x32x16_bf16 v[56:71], v[156:159], v[44:47], v[56:71]
  v_exp_f32 v37, v37
  s_mov_b64 exec, s[22:23]
  buffer_load_dwordx4 v[160:163], v2, s[36:39], s61 offen offset:1024 sc1
  buffer_load_dwordx4 v[164:167], v2, s[36:39], s61 offen offset:2048 sc1
  s_mov_b64 exec, -1
  s_add_u32 s61, s61, 14336
  s_min_u32 s61, s61, 10056192
  v_cvt_pk_bf16_f32 v53, v34, v35
  v_exp_f32 v38, v38
  v_exp_f32 v39, v39
  v_cvt_pk_bf16_f32 v54, v36, v37
  v_cvt_pk_bf16_f32 v55, v38, v39
  v_mfma_f32_32x32x16_bf16 v[24:39], v[144:147], v[132:135], 0
  v_exp_f32 v8, v8
  v_exp_f32 v9, v9
  v_exp_f32 v10, v10
  v_exp_f32 v11, v11
  v_exp_f32 v12, v12
  v_cvt_pk_bf16_f32 v40, v8, v9
  v_mfma_f32_32x32x8bf16_1k v[24:39], v[4:5], v[142:143], v[24:39]
  v_exp_f32 v13, v13
  v_exp_f32 v14, v14
  v_cvt_pk_bf16_f32 v41, v10, v11
  v_exp_f32 v15, v15
  v_exp_f32 v16, v16
  v_cvt_pk_bf16_f32 v42, v12, v13
  v_mfma_f32_32x32x16_bf16 v[72:87], v[152:155], v[48:51], v[72:87]
  v_exp_f32 v17, v17
  v_cvt_pk_bf16_f32 v43, v14, v15
  v_exp_f32 v18, v18
  v_exp_f32 v19, v19
  v_cvt_pk_bf16_f32 v44, v16, v17
  v_exp_f32 v20, v20
  v_mfma_f32_32x32x16_bf16 v[72:87], v[156:159], v[52:55], v[72:87]
  v_exp_f32 v21, v21
  v_cvt_pk_bf16_f32 v45, v18, v19
  v_exp_f32 v22, v22
  v_exp_f32 v23, v23
  v_cvt_pk_bf16_f32 v46, v20, v21
  v_cvt_pk_bf16_f32 v47, v22, v23
  s_waitcnt vmcnt(2)
  v_mfma_f32_32x32x16_bf16 v[8:23], v[148:151], v[120:123], 0
  v_exp_f32 v24, v24
  v_exp_f32 v25, v25
  v_exp_f32 v26, v26
  v_exp_f32 v27, v27
  v_exp_f32 v28, v28
  v_cvt_pk_bf16_f32 v48, v24, v25
  v_mfma_f32_32x32x8bf16_1k v[8:23], v[6:7], v[136:137], v[8:23]
  v_exp_f32 v29, v29
  v_exp_f32 v30, v30
  v_cvt_pk_bf16_f32 v49, v26, v27
  v_exp_f32 v31, v31
  v_exp_f32 v32, v32
  v_cvt_pk_bf16_f32 v50, v28, v29
  v_mfma_f32_32x32x16_bf16 v[88:103], v[152:155], v[40:43], v[88:103]
  v_exp_f32 v33, v33
  v_cvt_pk_bf16_f32 v51, v30, v31
  v_exp_f32 v34, v34
  v_exp_f32 v35, v35
  v_cvt_pk_bf16_f32 v52, v32, v33
  v_exp_f32 v36, v36
  v_mfma_f32_32x32x16_bf16 v[88:103], v[156:159], v[44:47], v[88:103]
  v_exp_f32 v37, v37
  buffer_load_dwordx4 v[144:147], v2, s[36:39], s60 offen sc1
  s_mov_b32 exec_hi, 0
  buffer_load_dwordx2 v[4:5], v3, s[36:39], s60 offen offset:3072 sc1
  s_mov_b32 exec_hi, -1
  s_add_u32 s60, s60, 14336
  s_min_u32 s60, s60, 10056192
  v_cvt_pk_bf16_f32 v53, v34, v35
  v_exp_f32 v38, v38
  v_exp_f32 v39, v39
  v_cvt_pk_bf16_f32 v54, v36, v37
  v_cvt_pk_bf16_f32 v55, v38, v39
LF_ain:
  v_mfma_f32_32x32x16_bf16 v[24:39], v[148:151], v[124:127], 0
  v_exp_f32 v8, v8
  v_exp_f32 v9, v9
  v_exp_f32 v10, v10
  v_exp_f32 v11, v11
  v_exp_f32 v12, v12
  v_cvt_pk_bf16_f32 v40, v8, v9
  v_mfma_f32_32x32x8bf16_1k v[24:39], v[6:7], v[138:139], v[24:39]
  v_exp_f32 v13, v13
  v_exp_f32 v14, v14
  v_cvt_pk_bf16_f32 v41, v10, v11
  v_exp_f32 v15, v15
  v_exp_f32 v16, v16
  v_cvt_pk_bf16_f32 v42, v12, v13
  v_mfma_f32_32x32x16_bf16 v[104:119], v[152:155], v[48:51], v[104:119]
  v_exp_f32 v17, v17
  v_cvt_pk_bf16_f32 v43, v14, v15
  v_exp_f32 v18, v18
  v_exp_f32 v19, v19
  v_cvt_pk_bf16_f32 v44, v16, v17
  v_exp_f32 v20, v20
  v_mfma_f32_32x32x16_bf16 v[104:119], v[156:159], v[52:55], v[104:119]
  v_exp_f32 v21, v21
  v_cvt_pk_bf16_f32 v45, v18, v19
  v_exp_f32 v22, v22
  v_exp_f32 v23, v23
  v_cvt_pk_bf16_f32 v46, v20, v21
  v_cvt_pk_bf16_f32 v47, v22, v23
  v_mfma_f32_32x32x16_bf16 v[8:23], v[148:151], v[128:131], 0
  v_exp_f32 v24, v24
  v_exp_f32 v25, v25
  v_exp_f32 v26, v26
  v_exp_f32 v27, v27
  v_exp_f32 v28, v28
  v_cvt_pk_bf16_f32 v48, v24, v25
  v_mfma_f32_32x32x8bf16_1k v[8:23], v[6:7], v[140:141], v[8:23]
  v_exp_f32 v29, v29
  v_exp_f32 v30, v30
  v_cvt_pk_bf16_f32 v49, v26, v27
  v_exp_f32 v31, v31
  v_exp_f32 v32, v32
  v_cvt_pk_bf16_f32 v50, v28, v29
  s_waitcnt vmcnt(2)
  v_mfma_f32_32x32x16_bf16 v[56:71], v[160:163], v[40:43], v[56:71]
  v_exp_f32 v33, v33
  v_cvt_pk_bf16_f32 v51, v30, v31
  v_exp_f32 v34, v34
  v_exp_f32 v35, v35
  v_cvt_pk_bf16_f32 v52, v32, v33
  v_exp_f32 v36, v36
  v_mfma_f32_32x32x16_bf16 v[56:71], v[164:167], v[44:47], v[56:71]
  v_exp_f32 v37, v37
  s_mov_b64 exec, s[22:23]
  buffer_load_dwordx4 v[152:155], v2, s[36:39], s61 offen offset:1024 sc1
  buffer_load_dwordx4 v[156:159], v2, s[36:39], s61 offen offset:2048 sc1
  s_mov_b64 exec, -1
  s_add_u32 s61, s61, 14336
  s_min_u32 s61, s61, 10056192
  v_cvt_pk_bf16_f32 v53, v34, v35
  v_exp_f32 v38, v38
  v_exp_f32 v39, v39
  v_cvt_pk_bf16_f32 v54, v36, v37
  v_cvt_pk_bf16_f32 v55, v38, v39
  v_mfma_f32_32x32x16_bf16 v[24:39], v[148:151], v[132:135], 0
  v_exp_f32 v8, v8
  v_exp_f32 v9, v9
  v_exp_f32 v10, v10
  v_exp_f32 v11, v11
  v_exp_f32 v12, v12
  v_cvt_pk_bf16_f32 v40, v8, v9
  v_mfma_f32_32x32x8bf16_1k v[24:39], v[6:7], v[142:143], v[24:39]
  v_exp_f32 v13, v13
  v_exp_f32 v14, v14
  v_cvt_pk_bf16_f32 v41, v10, v11
  v_exp_f32 v15, v15
  v_exp_f32 v16, v16
  v_cvt_pk_bf16_f32 v42, v12, v13
  v_mfma_f32_32x32x16_bf16 v[72:87], v[160:163], v[48:51], v[72:87]
  v_exp_f32 v17, v17
  v_cvt_pk_bf16_f32 v43, v14, v15
  v_exp_f32 v18, v18
  v_exp_f32 v19, v19
  v_cvt_pk_bf16_f32 v44, v16, v17
  v_exp_f32 v20, v20
  v_mfma_f32_32x32x16_bf16 v[72:87], v[164:167], v[52:55], v[72:87]
  v_exp_f32 v21, v21
  v_cvt_pk_bf16_f32 v45, v18, v19
  v_exp_f32 v22, v22
  v_exp_f32 v23, v23
  v_cvt_pk_bf16_f32 v46, v20, v21
  v_cvt_pk_bf16_f32 v47, v22, v23
  s_waitcnt vmcnt(2)
  v_mfma_f32_32x32x16_bf16 v[8:23], v[144:147], v[120:123], 0
  v_exp_f32 v24, v24
  v_exp_f32 v25, v25
  v_exp_f32 v26, v26
  v_exp_f32 v27, v27
  v_exp_f32 v28, v28
  v_cvt_pk_bf16_f32 v48, v24, v25
  v_mfma_f32_32x32x8bf16_1k v[8:23], v[4:5], v[136:137], v[8:23]
  v_exp_f32 v29, v29
  v_exp_f32 v30, v30
  v_cvt_pk_bf16_f32 v49, v26, v27
  v_exp_f32 v31, v31
  v_exp_f32 v32, v32
  v_cvt_pk_bf16_f32 v50, v28, v29
  v_mfma_f32_32x32x16_bf16 v[88:103], v[160:163], v[40:43], v[88:103]
  v_exp_f32 v33, v33
  v_cvt_pk_bf16_f32 v51, v30, v31
  v_exp_f32 v34, v34
  v_exp_f32 v35, v35
  v_cvt_pk_bf16_f32 v52, v32, v33
  v_exp_f32 v36, v36
  v_mfma_f32_32x32x16_bf16 v[88:103], v[164:167], v[44:47], v[88:103]
  v_exp_f32 v37, v37
  buffer_load_dwordx4 v[148:151], v2, s[36:39], s60 offen sc1
  s_mov_b32 exec_hi, 0
  buffer_load_dwordx2 v[6:7], v3, s[36:39], s60 offen offset:3072 sc1
  s_mov_b32 exec_hi, -1
  s_add_u32 s60, s60, 14336
  s_min_u32 s60, s60, 10056192
  v_cvt_pk_bf16_f32 v53, v34, v35
  v_exp_f32 v38, v38
  v_exp_f32 v39, v39
  v_cvt_pk_bf16_f32 v54, v36, v37
  v_cvt_pk_bf16_f32 v55, v38, v39
  s_sub_u32 s46, s46, 1
  s_cmp_gt_u32 s46, 3
  s_cbranch_scc1 LF_aloop
  s_setprio 1
  s_cmp_gt_u32 s46, 1
  s_cbranch_scc1 LF_aloop
  s_setprio 0
  s_cmp_lg_u32 s46, 0
  s_cbranch_scc1 LF_aloop
  v_mfma_f32_32x32x16_bf16 v[104:119], v[160:163], v[48:51], v[104:119]
  v_mfma_f32_32x32x16_bf16 v[104:119], v[164:167], v[52:55], v[104:119]
  s_setprio 2
  v_and_b32 v13, 3, v1
  v_lshlrev_b32 v13, 8, v13
  v_add_u32 v13, 160768, v13
  s_lshr_b32 s50, s40, 2
  s_lshl_b32 s48, s50, 10
  s_add_u32 s48, s48, 1024
  v_add_u32 v14, s48, v13
  s_lshl_b32 s48, s40, 8
  s_add_u32 s48, s48, 161792
  v_lshl_add_u32 v15, v1, 2, s48
  v_mov_b32 v17, 6
  s_add_u32 s50, s50, 30
  s_mul_i32 s48, s40, 9216
  s_add_u32 s48, s48, 49152
  v_add_u32 v8, s48, v2
  s_xor_b32 s48, s40, 1
  s_mul_i32 s48, s48, 9216
  s_add_u32 s48, s48, 49152
  v_add_u32 v9, s48, v2
  s_xor_b32 s48, s40, 2
  s_mul_i32 s48, s48, 9216
  s_add_u32 s48, s48, 49152
  v_add_u32 v10, s48, v2
  s_xor_b32 s48, s40, 3
  s_mul_i32 s48, s48, 9216
  s_add_u32 s48, s48, 49152
  v_add_u32 v11, s48, v2
LF_sp8:
  ds_read_b32 v16, v13
  s_waitcnt lgkmcnt(0)
  v_cmp_gt_u32 vcc, s50, v16
  s_nop 0
  s_cbranch_vccz LF_sp8d
  s_sleep 1
  s_branch LF_sp8
LF_sp8d:
  ds_write_b128 v9, v[72:75] offset:0
  ds_write_b128 v9, v[76:79] offset:1024
  ds_write_b128 v9, v[80:83] offset:2048
  ds_write_b128 v10, v[88:91] offset:3072
  ds_write_b128 v10, v[92:95] offset:4096
  ds_write_b128 v10, v[96:99] offset:5120
  ds_write_b128 v11, v[104:107] offset:6144
  ds_write_b128 v11, v[108:111] offset:7168
  ds_write_b128 v11, v[112:115] offset:8192
  s_waitcnt lgkmcnt(0)
  ds_write_b32 v15, v17
  s_lshr_b32 s48, s40, 2
  s_mul_i32 s48, s48, 5
  v_lshrrev_b32 v29, 5, v1
  v_add_u32 v29, s48, v29
  v_and_b32 v26, 0x1f0, v2
  v_lshrrev_b32 v27, 1, v29
  v_lshl_add_u32 v27, v27, 9, v26
  v_and_b32 v29, 1, v29
  v_lshl_add_u32 v27, v29, 3, v27
  s_mul_i32 s61, s47, 96256
  s_add_u32 s61, s61, 10092544
  s_mul_i32 s60, s63, 2560
  s_add_u32 s60, s60, 147456
  v_add_u32 v27, s60, v27
  v_mov_b32 v32, v13
  v_mov_b32 v33, v14
  v_mov_b32 v34, v15
LF_sp9:
  ds_read_b32 v16, v14
  s_waitcnt lgkmcnt(0)
  v_cmp_gt_u32 vcc, 6, v16
  s_nop 0
  s_cbranch_vccz LF_sp9d
  s_sleep 1
  s_branch LF_sp9
LF_sp9d:
  ds_read_b128 v[72:75], v8 offset:0
  ds_read_b128 v[76:79], v8 offset:1024
  ds_read_b128 v[80:83], v8 offset:2048
  ds_read_b128 v[88:91], v8 offset:3072
  ds_read_b128 v[92:95], v8 offset:4096
  ds_read_b128 v[96:99], v8 offset:5120
  ds_read_b128 v[104:107], v8 offset:6144
  ds_read_b128 v[108:111], v8 offset:7168
  ds_read_b128 v[112:115], v8 offset:8192
  s_waitcnt lgkmcnt(6)
  v_add_f32 v56, v56, v72
  v_add_f32 v57, v57, v73
  v_add_f32 v58, v58, v74
  v_add_f32 v59, v59, v75
  v_add_f32 v60, v60, v76
  v_add_f32 v61, v61, v77
  v_add_f32 v62, v62, v78
  v_add_f32 v63, v63, v79
  v_add_f32 v64, v64, v80
  v_add_f32 v65, v65, v81
  v_add_f32 v66, v66, v82
  v_add_f32 v67, v67, v83
  s_waitcnt lgkmcnt(3)
  v_add_f32 v56, v56, v88
  v_add_f32 v57, v57, v89
  v_add_f32 v58, v58, v90
  v_add_f32 v59, v59, v91
  v_add_f32 v60, v60, v92
  v_add_f32 v61, v61, v93
  v_add_f32 v62, v62, v94
  v_add_f32 v63, v63, v95
  v_add_f32 v64, v64, v96
  v_add_f32 v65, v65, v97
  v_add_f32 v66, v66, v98
  v_add_f32 v67, v67, v99
  s_waitcnt lgkmcnt(0)
  v_add_f32 v56, v56, v104
  v_add_f32 v57, v57, v105
  v_add_f32 v58, v58, v106
  v_add_f32 v59, v59, v107
  v_add_f32 v60, v60, v108
  v_add_f32 v61, v61, v109
  v_add_f32 v62, v62, v110
  v_add_f32 v63, v63, v111
  v_add_f32 v64, v64, v112
  v_add_f32 v65, v65, v113
  v_add_f32 v66, v66, v114
  v_add_f32 v67, v67, v115
  v_mov_b32 v24, v64
  v_mov_b32 v28, v64
  s_nop 1
  v_permlane32_swap_b32 v28, v24
  v_add_f32 v25, |v56|, |v57|
  v_add_f32 v25, v25, |v58|
  v_add_f32 v25, v25, |v59|
  v_add_f32 v25, v25, |v60|
  v_add_f32 v25, v25, |v61|
  v_add_f32 v25, v25, |v62|
  v_add_f32 v25, v25, |v63|
  v_add_f32 v26, v25, |v64|
  v_add_f32 v26, v26, |v65|
  v_add_f32 v26, v26, |v66|
  v_add_f32 v26, v26, |v67|
  s_mov_b32 s48, 0x7d800000
  s_mov_b32 s49, 0x0a800000
  s_mov_b32 s50, 0x7e800000
  v_cmp_gt_f32 s[20:21], s48, v24
  v_cmp_le_f32 s[54:55], s49, v25
  v_cmp_gt_f32 vcc, s50, v26
  s_nop 1
  s_and_b64 s[20:21], s[20:21], s[54:55]
  s_and_b64 s[20:21], s[20:21], vcc
  s_cmp_eq_u64 s[20:21], -1
  s_cbranch_scc0 LF_fallback
LF_final:
  v_rcp_f32 v24, v24
  s_nop 0
  v_mul_f32 v56, v56, v24
  v_mul_f32 v57, v57, v24
  v_mul_f32 v58, v58, v24
  v_mul_f32 v59, v59, v24
  v_mul_f32 v60, v60, v24
  v_mul_f32 v61, v61, v24
  v_mul_f32 v62, v62, v24
  v_mul_f32 v63, v63, v24
  v_mul_f32 v64, v64, v24
  v_mul_f32 v65, v65, v24
  v_mul_f32 v66, v66, v24
  v_mul_f32 v67, v67, v24
  v_cvt_pk_bf16_f32 v40, v56, v57
  v_cvt_pk_bf16_f32 v41, v58, v59
  v_cvt_pk_bf16_f32 v42, v60, v61
  v_cvt_pk_bf16_f32 v43, v62, v63
  v_cvt_pk_bf16_f32 v44, v64, v65
  v_cvt_pk_bf16_f32 v45, v66, v67
  ds_write_b64 v27, v[40:41]
  ds_write_b64 v27, v[42:43] offset:512
  s_mov_b32 exec_hi, 0
  ds_write_b64 v27, v[44:45] offset:1024
  s_mov_b64 exec, -1
  s_branch LF_p3
LF_fallback:
  s_waitcnt vmcnt(0)
  v_cndmask_b32 v136, v136, 0, s[52:53]
  v_cndmask_b32 v137, v137, 0, s[52:53]
  v_mov_b32 v48, 0xff800000
  s_mov_b32 s48, 9830400
  s_mov_b32 s46, 16
  buffer_load_dwordx4 v[72:75], v2, s[36:39], s48 offen sc1
  buffer_load_dwordx2 v[76:77], v3, s[36:39], s48 offen offset:3072 sc1
  s_add_u32 s48, s48, 3584
  s_min_u32 s48, s48, 10056192
  buffer_load_dwordx4 v[88:91], v2, s[36:39], s48 offen sc1
  buffer_load_dwordx2 v[92:93], v3, s[36:39], s48 offen offset:3072 sc1
  s_add_u32 s48, s48, 3584
  s_min_u32 s48, s48, 10056192
  buffer_load_dwordx4 v[104:107], v2, s[36:39], s48 offen sc1
  buffer_load_dwordx2 v[108:109], v3, s[36:39], s48 offen offset:3072 sc1
  s_add_u32 s48, s48, 3584
  s_min_u32 s48, s48, 10056192
  buffer_load_dwordx4 v[152:155], v2, s[36:39], s48 offen sc1
  buffer_load_dwordx2 v[156:157], v3, s[36:39], s48 offen offset:3072 sc1
  s_add_u32 s48, s48, 3584
  s_min_u32 s48, s48, 10056192
LF_fb0:
  s_waitcnt vmcnt(6)
  v_mfma_f32_32x32x16_bf16 v[8:23], v[72:75], v[120:123], 0
  v_mfma_f32_32x32x8bf16_1k v[8:23], v[76:77], v[136:137], v[8:23]
  buffer_load_dwordx4 v[72:75], v2, s[36:39], s48 offen sc1
  buffer_load_dwordx2 v[76:77], v3, s[36:39], s48 offen offset:3072 sc1
  s_add_u32 s48, s48, 3584
  s_min_u32 s48, s48, 10056192
  s_nop 11
  v_max3_f32 v48, v48, v8, v9
  v_max3_f32 v48, v48, v10, v11
  v_max3_f32 v48, v48, v12, v13
  v_max3_f32 v48, v48, v14, v15
  v_max3_f32 v48, v48, v16, v17
  v_max3_f32 v48, v48, v18, v19
  v_max3_f32 v48, v48, v20, v21
  v_max3_f32 v48, v48, v22, v23
  s_waitcnt vmcnt(6)
  v_mfma_f32_32x32x16_bf16 v[8:23], v[88:91], v[120:123], 0
  v_mfma_f32_32x32x8bf16_1k v[8:23], v[92:93], v[136:137], v[8:23]
  buffer_load_dwordx4 v[88:91], v2, s[36:39], s48 offen sc1
  buffer_load_dwordx2 v[92:93], v3, s[36:39], s48 offen offset:3072 sc1
  s_add_u32 s48, s48, 3584
  s_min_u32 s48, s48, 10056192
  s_nop 11
  v_max3_f32 v48, v48, v8, v9
  v_max3_f32 v48, v48, v10, v11
  v_max3_f32 v48, v48, v12, v13
  v_max3_f32 v48, v48, v14, v15
  v_max3_f32 v48, v48, v16, v17
  v_max3_f32 v48, v48, v18, v19
  v_max3_f32 v48, v48, v20, v21
  v_max3_f32 v48, v48, v22, v23
  s_waitcnt vmcnt(6)
  v_mfma_f32_32x32x16_bf16 v[8:23], v[104:107], v[120:123], 0
  v_mfma_f32_32x32x8bf16_1k v[8:23], v[108:109], v[136:137], v[8:23]
  buffer_load_dwordx4 v[104:107], v2, s[36:39], s48 offen sc1
  buffer_load_dwordx2 v[108:109], v3, s[36:39], s48 offen offset:3072 sc1
  s_add_u32 s48, s48, 3584
  s_min_u32 s48, s48, 10056192
  s_nop 11
  v_max3_f32 v48, v48, v8, v9
  v_max3_f32 v48, v48, v10, v11
  v_max3_f32 v48, v48, v12, v13
  v_max3_f32 v48, v48, v14, v15
  v_max3_f32 v48, v48, v16, v17
  v_max3_f32 v48, v48, v18, v19
  v_max3_f32 v48, v48, v20, v21
  v_max3_f32 v48, v48, v22, v23
  s_waitcnt vmcnt(6)
  v_mfma_f32_32x32x16_bf16 v[8:23], v[152:155], v[120:123], 0
  v_mfma_f32_32x32x8bf16_1k v[8:23], v[156:157], v[136:137], v[8:23]
  buffer_load_dwordx4 v[152:155], v2, s[36:39], s48 offen sc1
  buffer_load_dwordx2 v[156:157], v3, s[36:39], s48 offen offset:3072 sc1
  s_add_u32 s48, s48, 3584
  s_min_u32 s48, s48, 10056192
  s_nop 11
  v_max3_f32 v48, v48, v8, v9
  v_max3_f32 v48, v48, v10, v11
  v_max3_f32 v48, v48, v12, v13
  v_max3_f32 v48, v48, v14, v15
  v_max3_f32 v48, v48, v16, v17
  v_max3_f32 v48, v48, v18, v19
  v_max3_f32 v48, v48, v20, v21
  v_max3_f32 v48, v48, v22, v23
  s_sub_u32 s46, s46, 1
  s_cmp_lg_u32 s46, 0
  s_cbranch_scc1 LF_fb0
  s_waitcnt vmcnt(0)
  v_mov_b32 v49, v48
  s_nop 1
  v_permlane32_swap_b32 v49, v48
  s_nop 0
  v_max_f32 v48, v48, v49
  v_cvt_pk_bf16_f32 v50, -v48, -v48
  v_lshlrev_b32 v50, 16, v50
  v_add_f32 v51, v48, v50
  v_cvt_pk_bf16_f32 v52, v50, -v51
  v_and_b32 v50, 0xffff0000, v52
  v_add_f32 v51, v51, v50
  v_cvt_pk_bf16_f32 v53, -v51, 0
  v_cndmask_b32 v136, v136, v52, s[52:53]
  v_cndmask_b32 v137, v137, v53, s[52:53]
  v_mov_b32 v56, 0
  v_mov_b32 v57, 0
  v_mov_b32 v58, 0
  v_mov_b32 v59, 0
  v_mov_b32 v60, 0
  v_mov_b32 v61, 0
  v_mov_b32 v62, 0
  v_mov_b32 v63, 0
  v_mov_b32 v64, 0
  v_mov_b32 v65, 0
  v_mov_b32 v66, 0
  v_mov_b32 v67, 0
  v_mov_b32 v68, 0
  v_mov_b32 v69, 0
  v_mov_b32 v70, 0
  v_mov_b32 v71, 0
  s_mov_b32 s48, 9830400
  s_mov_b32 s46, 16
  buffer_load_dwordx4 v[72:75], v2, s[36:39], s48 offen sc1
  buffer_load_dwordx2 v[76:77], v3, s[36:39], s48 offen offset:3072 sc1
  buffer_load_dwordx4 v[80:83], v2, s[36:39], s48 offen offset:1024 sc1
  buffer_load_dwordx4 v[84:87], v2, s[36:39], s48 offen offset:2048 sc1
  s_add_u32 s48, s48, 3584
  s_min_u32 s48, s48, 10056192
  buffer_load_dwordx4 v[88:91], v2, s[36:39], s48 offen sc1
  buffer_load_dwordx2 v[92:93], v3, s[36:39], s48 offen offset:3072 sc1
  buffer_load_dwordx4 v[96:99], v2, s[36:39], s48 offen offset:1024 sc1
  buffer_load_dwordx4 v[100:103], v2, s[36:39], s48 offen offset:2048 sc1
  s_add_u32 s48, s48, 3584
  s_min_u32 s48, s48, 10056192
  buffer_load_dwordx4 v[104:107], v2, s[36:39], s48 offen sc1
  buffer_load_dwordx2 v[108:109], v3, s[36:39], s48 offen offset:3072 sc1
  buffer_load_dwordx4 v[112:115], v2, s[36:39], s48 offen offset:1024 sc1
  buffer_load_dwordx4 v[116:119], v2, s[36:39], s48 offen offset:2048 sc1
  s_add_u32 s48, s48, 3584
  s_min_u32 s48, s48, 10056192
  buffer_load_dwordx4 v[152:155], v2, s[36:39], s48 offen sc1
  buffer_load_dwordx2 v[156:157], v3, s[36:39], s48 offen offset:3072 sc1
  buffer_load_dwordx4 v[160:163], v2, s[36:39], s48 offen offset:1024 sc1
  buffer_load_dwordx4 v[164:167], v2, s[36:39], s48 offen offset:2048 sc1
  s_add_u32 s48, s48, 3584
  s_min_u32 s48, s48, 10056192
LF_fb1:
  s_waitcnt vmcnt(12)
  v_mfma_f32_32x32x16_bf16 v[8:23], v[72:75], v[120:123], 0
  v_mfma_f32_32x32x8bf16_1k v[8:23], v[76:77], v[136:137], v[8:23]
  s_nop 11
  v_exp_f32 v8, v8
  v_exp_f32 v9, v9
  v_exp_f32 v10, v10
  v_exp_f32 v11, v11
  v_exp_f32 v12, v12
  v_exp_f32 v13, v13
  v_exp_f32 v14, v14
  v_exp_f32 v15, v15
  v_exp_f32 v16, v16
  v_exp_f32 v17, v17
  v_exp_f32 v18, v18
  v_exp_f32 v19, v19
  v_exp_f32 v20, v20
  v_exp_f32 v21, v21
  v_exp_f32 v22, v22
  v_exp_f32 v23, v23
  s_nop 0
  v_cvt_pk_bf16_f32 v40, v8, v9
  v_cvt_pk_bf16_f32 v41, v10, v11
  v_cvt_pk_bf16_f32 v42, v12, v13
  v_cvt_pk_bf16_f32 v43, v14, v15
  v_cvt_pk_bf16_f32 v44, v16, v17
  v_cvt_pk_bf16_f32 v45, v18, v19
  v_cvt_pk_bf16_f32 v46, v20, v21
  v_cvt_pk_bf16_f32 v47, v22, v23
  s_nop 1
  v_mfma_f32_32x32x16_bf16 v[56:71], v[80:83], v[40:43], v[56:71]
  v_mfma_f32_32x32x16_bf16 v[56:71], v[84:87], v[44:47], v[56:71]
  buffer_load_dwordx4 v[72:75], v2, s[36:39], s48 offen sc1
  buffer_load_dwordx2 v[76:77], v3, s[36:39], s48 offen offset:3072 sc1
  buffer_load_dwordx4 v[80:83], v2, s[36:39], s48 offen offset:1024 sc1
  buffer_load_dwordx4 v[84:87], v2, s[36:39], s48 offen offset:2048 sc1
  s_add_u32 s48, s48, 3584
  s_min_u32 s48, s48, 10056192
  s_waitcnt vmcnt(12)
  v_mfma_f32_32x32x16_bf16 v[8:23], v[88:91], v[120:123], 0
  v_mfma_f32_32x32x8bf16_1k v[8:23], v[92:93], v[136:137], v[8:23]
  s_nop 11
  v_exp_f32 v8, v8
  v_exp_f32 v9, v9
  v_exp_f32 v10, v10
  v_exp_f32 v11, v11
  v_exp_f32 v12, v12
  v_exp_f32 v13, v13
  v_exp_f32 v14, v14
  v_exp_f32 v15, v15
  v_exp_f32 v16, v16
  v_exp_f32 v17, v17
  v_exp_f32 v18, v18
  v_exp_f32 v19, v19
  v_exp_f32 v20, v20
  v_exp_f32 v21, v21
  v_exp_f32 v22, v22
  v_exp_f32 v23, v23
  s_nop 0
  v_cvt_pk_bf16_f32 v40, v8, v9
  v_cvt_pk_bf16_f32 v41, v10, v11
  v_cvt_pk_bf16_f32 v42, v12, v13
  v_cvt_pk_bf16_f32 v43, v14, v15
  v_cvt_pk_bf16_f32 v44, v16, v17
  v_cvt_pk_bf16_f32 v45, v18, v19
  v_cvt_pk_bf16_f32 v46, v20, v21
  v_cvt_pk_bf16_f32 v47, v22, v23
  s_nop 1
  v_mfma_f32_32x32x16_bf16 v[56:71], v[96:99], v[40:43], v[56:71]
  v_mfma_f32_32x32x16_bf16 v[56:71], v[100:103], v[44:47], v[56:71]
  buffer_load_dwordx4 v[88:91], v2, s[36:39], s48 offen sc1
  buffer_load_dwordx2 v[92:93], v3, s[36:39], s48 offen offset:3072 sc1
  buffer_load_dwordx4 v[96:99], v2, s[36:39], s48 offen offset:1024 sc1
  buffer_load_dwordx4 v[100:103], v2, s[36:39], s48 offen offset:2048 sc1
  s_add_u32 s48, s48, 3584
  s_min_u32 s48, s48, 10056192
  s_waitcnt vmcnt(12)
  v_mfma_f32_32x32x16_bf16 v[8:23], v[104:107], v[120:123], 0
  v_mfma_f32_32x32x8bf16_1k v[8:23], v[108:109], v[136:137], v[8:23]
  s_nop 11
  v_exp_f32 v8, v8
  v_exp_f32 v9, v9
  v_exp_f32 v10, v10
  v_exp_f32 v11, v11
  v_exp_f32 v12, v12
  v_exp_f32 v13, v13
  v_exp_f32 v14, v14
  v_exp_f32 v15, v15
  v_exp_f32 v16, v16
  v_exp_f32 v17, v17
  v_exp_f32 v18, v18
  v_exp_f32 v19, v19
  v_exp_f32 v20, v20
  v_exp_f32 v21, v21
  v_exp_f32 v22, v22
  v_exp_f32 v23, v23
  s_nop 0
  v_cvt_pk_bf16_f32 v40, v8, v9
  v_cvt_pk_bf16_f32 v41, v10, v11
  v_cvt_pk_bf16_f32 v42, v12, v13
  v_cvt_pk_bf16_f32 v43, v14, v15
  v_cvt_pk_bf16_f32 v44, v16, v17
  v_cvt_pk_bf16_f32 v45, v18, v19
  v_cvt_pk_bf16_f32 v46, v20, v21
  v_cvt_pk_bf16_f32 v47, v22, v23
  s_nop 1
  v_mfma_f32_32x32x16_bf16 v[56:71], v[112:115], v[40:43], v[56:71]
  v_mfma_f32_32x32x16_bf16 v[56:71], v[116:119], v[44:47], v[56:71]
  buffer_load_dwordx4 v[104:107], v2, s[36:39], s48 offen sc1
  buffer_load_dwordx2 v[108:109], v3, s[36:39], s48 offen offset:3072 sc1
  buffer_load_dwordx4 v[112:115], v2, s[36:39], s48 offen offset:1024 sc1
  buffer_load_dwordx4 v[116:119], v2, s[36:39], s48 offen offset:2048 sc1
  s_add_u32 s48, s48, 3584
  s_min_u32 s48, s48, 10056192
  s_waitcnt vmcnt(12)
  v_mfma_f32_32x32x16_bf16 v[8:23], v[152:155], v[120:123], 0
  v_mfma_f32_32x32x8bf16_1k v[8:23], v[156:157], v[136:137], v[8:23]
  s_nop 11
  v_exp_f32 v8, v8
  v_exp_f32 v9, v9
  v_exp_f32 v10, v10
  v_exp_f32 v11, v11
  v_exp_f32 v12, v12
  v_exp_f32 v13, v13
  v_exp_f32 v14, v14
  v_exp_f32 v15, v15
  v_exp_f32 v16, v16
  v_exp_f32 v17, v17
  v_exp_f32 v18, v18
  v_exp_f32 v19, v19
  v_exp_f32 v20, v20
  v_exp_f32 v21, v21
  v_exp_f32 v22, v22
  v_exp_f32 v23, v23
  s_nop 0
  v_cvt_pk_bf16_f32 v40, v8, v9
  v_cvt_pk_bf16_f32 v41, v10, v11
  v_cvt_pk_bf16_f32 v42, v12, v13
  v_cvt_pk_bf16_f32 v43, v14, v15
  v_cvt_pk_bf16_f32 v44, v16, v17
  v_cvt_pk_bf16_f32 v45, v18, v19
  v_cvt_pk_bf16_f32 v46, v20, v21
  v_cvt_pk_bf16_f32 v47, v22, v23
  s_nop 1
  v_mfma_f32_32x32x16_bf16 v[56:71], v[160:163], v[40:43], v[56:71]
  v_mfma_f32_32x32x16_bf16 v[56:71], v[164:167], v[44:47], v[56:71]
  buffer_load_dwordx4 v[152:155], v2, s[36:39], s48 offen sc1
  buffer_load_dwordx2 v[156:157], v3, s[36:39], s48 offen offset:3072 sc1
  buffer_load_dwordx4 v[160:163], v2, s[36:39], s48 offen offset:1024 sc1
  buffer_load_dwordx4 v[164:167], v2, s[36:39], s48 offen offset:2048 sc1
  s_add_u32 s48, s48, 3584
  s_min_u32 s48, s48, 10056192
  s_sub_u32 s46, s46, 1
  s_cmp_lg_u32 s46, 0
  s_cbranch_scc1 LF_fb1
  s_waitcnt vmcnt(0)
  s_nop 8
  v_mov_b32 v24, v64
  v_mov_b32 v28, v64
  s_nop 1
  v_permlane32_swap_b32 v28, v24
  s_branch LF_final
LF_p3:
  v_mov_b32 v72, 160256
  ds_read_b64 v[74:75], v72
  s_lshl2_add_u32 s48, s63, 160384
  v_mov_b32 v78, s48
  v_mov_b32 v72, 1
  s_waitcnt lgkmcnt(0)
  s_mov_b64 exec, 1
  ds_add_rtn_u32 v72, v78, v72
  s_mov_b64 exec, -1
  s_mul_i32 s48, s42, 2560
  s_add_u32 s61, s61, s48
  v_add_u32 v78, s60, v2
  s_lshl_b32 s49, s47, 8
  s_lshl3_add_u32 s49, s42, s49
  s_add_u32 s49, s49, 18890752
  s_waitcnt lgkmcnt(0)
  v_readfirstlane_b32 s50, v72
  s_nop 0
  s_cmp_eq_u32 s50, 0
  s_cbranch_scc1 LF_o1
  ds_read_b128 v[88:91], v78 offset:0
  ds_read_b128 v[92:95], v78 offset:1024
  ds_read_b128 v[96:99], v78 offset:2048
  s_waitcnt lgkmcnt(2)
  buffer_store_dwordx4 v[88:91], v2, s[36:39], s61 offen offset:0 sc0 sc1
  s_waitcnt lgkmcnt(1)
  buffer_store_dwordx4 v[92:95], v2, s[36:39], s61 offen offset:1024 sc0 sc1
  s_waitcnt lgkmcnt(0)
  s_mov_b32 exec_hi, 0
  buffer_store_dwordx4 v[96:99], v2, s[36:39], s61 offen offset:2048 sc0 sc1
  s_mov_b32 exec_hi, -1
LF_o1:
  s_cmp_eq_u32 s50, 0
  s_cbranch_scc1 LF_o2
  v_lshrrev_b32 v124, 0, v1
  v_lshlrev_b32 v124, 16, v124
  s_waitcnt vmcnt(0)
  s_mov_b32 exec_hi, 0
  s_mov_b32 exec_lo, 0x1
  buffer_store_dwordx2 v[74:75], v124, s[36:39], s49 offen sc0 sc1
  s_mov_b64 exec, -1
LF_o2:
  v_mov_b32 v72, 8
  ds_write_b32 v34, v72
  s_cmp_lg_u32 s40, 0
  s_cbranch_scc1 LF_fin
  s_setprio 1
  v_and_b32 v77, 7, v1
  v_lshlrev_b32 v77, 8, v77
  v_add_u32 v77, 161792, v77
  s_lshr_b32 s48, s45, 3
  s_lshl2_add_u32 s49, s44, s48
  s_lshl_b32 s49, s49, 9
  s_add_u32 s49, s49, 18890752
  v_and_b32 v78, 0x178, v3
  v_mov_b32 v76, 160352
LF_sp10:
  ds_read_b32 v72, v77
  s_waitcnt lgkmcnt(0)
  v_cmp_gt_u32 vcc, 8, v72
  s_nop 0
  s_cbranch_vccz LF_sp10d
  s_sleep 2
  s_branch LF_sp10
LF_sp10d:
  s_add_u32 s50, s49, 65536
  s_cmp_lt_u32 s42, 14
  s_cbranch_scc1 LF_oh
  v_mov_b32 v77, 160768
LF_sp11:
  ds_read_b32 v72, v77
  s_waitcnt lgkmcnt(0)
  v_cmp_gt_u32 vcc, 65, v72
  s_nop 0
  s_cbranch_vccz LF_sp11d
  s_sleep 8
  s_branch LF_sp11
LF_sp11d:
  s_sleep 90
LF_oh:
  s_sleep 18
  s_mov_b32 s50, s49
LF_ol:
  s_mov_b32 s48, 0x20000
LF_pl12:
  buffer_load_dwordx2 v[8:9], v78, s[36:39], s50 offen sc0 sc1
  s_waitcnt vmcnt(0)
  v_cmp_ne_u64 vcc, v[8:9], v[74:75]
  s_nop 0
  s_cbranch_vccz LF_pl12d
  s_sleep 8
  s_sub_u32 s48, s48, 1
  s_cbranch_scc0 LF_pl12
LF_pl12d:
LF_od:
  v_mov_b32 v72, 1
  ds_write_b32 v76, v72
  s_branch LF_fin
LF_ztail:
  v_lshlrev_b32 v13, 7, v1
  v_mov_b32 v25, 160256
  ds_read_b64 v[160:161], v25
  s_lshl_b32 s46, s41, 11
  s_lshl_b32 s49, s43, 10
  s_add_u32 s46, s46, s49
  s_add_u32 s46, s46, 19527680
  s_load_dwordx4 s[8:11], s[0:1], 56
  s_load_dwordx2 s[4:5], s[0:1], 32
  s_load_dwordx2 s[6:7], s[0:1], 72
  s_waitcnt vmcnt(18)
  s_cmp_eq_u32 s61, 0
  s_cbranch_scc1 LF_zw13
  s_waitcnt vmcnt(14)
  s_cmp_eq_u32 s61, 1
  s_cbranch_scc1 LF_zw13
  s_waitcnt vmcnt(12)
LF_zw13:
  s_barrier
  s_cmp_lt_u32 s43, 2
  s_cbranch_scc1 LF_xl14
  buffer_load_dwordx4 v[100:103], v2, s[36:39], s46 offen sc0 sc1
LF_xl14:
  s_lshr_b32 s48, s44, 1
  s_lshl_b32 s48, s48, 7
  s_lshl2_add_u32 s48, s45, s48
  s_add_u32 s48, s48, s43
  s_lshl_b32 s49, s48, 14
  s_and_b32 s48, s44, 1
  s_lshl_b32 s48, s48, 13
  s_add_u32 s49, s49, s48
  s_xor_b32 s48, s49, 8192
  s_waitcnt lgkmcnt(0)
  s_mov_b32 s24, s8
  s_mov_b32 s25, s9
  s_mov_b32 s26, 8388608
  s_mov_b32 s27, 0x20000
  s_mov_b32 s28, s10
  s_mov_b32 s29, s11
  s_mov_b32 s30, 4096
  s_mov_b32 s31, 0x20000
  buffer_load_dword v22, v13, s[24:27], s49 offen
  buffer_load_dword v22, v13, s[24:27], s48 offen
  v_and_b32 v6, 3, v1
  v_lshlrev_b32 v6, 8, v6
  v_add_u32 v6, 160768, v6
  v_and_b32 v31, 7, v1
  v_lshlrev_b32 v31, 8, v31
  v_add_u32 v31, 161792, v31
  s_sub_u32 s63, s42, 1
  s_cselect_b32 s63, 13, s63
  s_cmp_ge_u32 s42, 14
  s_cselect_b32 s63, 14, s63
  v_and_b32 v164, 31, v1
  v_lshrrev_b32 v165, 5, v1
  s_lshl_b32 s58, s43, 12
  s_add_u32 s50, s58, 98304
  v_lshlrev_b32 v24, 6, v164
  v_lshl_add_u32 v24, v165, 3, v24
  v_add_u32 v24, s50, v24
  v_bfe_u32 v23, v1, 2, 2
  v_lshl_add_u32 v23, v165, 3, v23
  v_lshlrev_b32 v23, 6, v23
  v_bfe_u32 v167, v1, 4, 1
  v_lshl_add_u32 v23, v167, 5, v23
  v_and_b32 v167, 3, v1
  v_lshl_add_u32 v23, v167, 3, v23
  v_add_u32 v23, s50, v23
  s_add_u32 s50, s58, 49152
  v_add_u32 v27, s50, v2
  s_waitcnt vmcnt(11)
  s_cmp_eq_u32 s61, 0
  s_cbranch_scc1 LF_zw15
  s_waitcnt vmcnt(9)
  s_cmp_eq_u32 s61, 1
  s_cbranch_scc1 LF_zw15
  s_waitcnt vmcnt(8)
LF_zw15:
  s_barrier
  s_lshl_b32 s59, s43, 11
  s_lshl_b32 s56, s41, 19
  s_lshl_b32 s48, s43, 17
  s_add_u32 s56, s56, s48
  s_lshr_b32 s50, s43, 1
  s_lshl1_add_u32 s14, s63, s50
  s_lshl_b32 s61, s14, 17
  s_add_u32 s61, s61, 6160384
  s_and_b32 s15, s43, 1
  s_lshl_b32 s48, s15, 11
  s_add_u32 s57, s61, s48
  s_mov_b32 s60, s56
  s_mul_i32 s48, s63, 9
  s_mul_i32 s49, s41, 0
  s_add_u32 s48, s48, s49
  s_bfe_u32 s48, s48, 0x50002
  s_lshl_b32 s49, s48, 7
  s_add_u32 s56, s56, s49
  s_lshl_b32 s49, s48, 12
  s_add_u32 s57, s57, s49
  v_lshrrev_b32 v166, 3, v1
  v_lshlrev_b32 v166, 12, v166
  v_lshrrev_b32 v167, 4, v1
  v_xor_b32 v167, v167, v1
  v_and_b32 v167, 7, v167
  v_lshl_add_u32 v4, v167, 4, v166
  v_xor_b32 v167, 4, v167
  v_lshl_add_u32 v5, v167, 4, v166
  v_add_u32 v5, 32768, v5
  v_bfe_u32 v166, v164, 1, 3
  v_xor_b32 v166, v166, v165
  s_lshl_b32 s49, s50, 2
  v_xor_b32 v166, s49, v166
  v_lshlrev_b32 v166, 4, v166
  v_lshl_add_u32 v166, v164, 7, v166
  s_lshl_b32 s48, s15, 13
  v_add_u32 v8, s48, v166
  v_xor_b32 v9, 32, v8
  s_waitcnt vmcnt(2)
  s_barrier
  s_cmp_lt_u32 s43, 2
  s_cbranch_scc1 LF_nxs
  v_cmp_ne_u64 vcc, v[102:103], v[160:161]
  s_lshl_b32 s49, s43, 9
  s_cbranch_vccz LF_xs1
  s_mov_b32 s48, 0x20000
LF_pl16:
  buffer_load_dwordx4 v[100:103], v2, s[36:39], s46 offen sc0 sc1
  s_waitcnt vmcnt(0)
  v_cmp_ne_u64 vcc, v[102:103], v[160:161]
  s_nop 0
  s_cbranch_vccz LF_pl16d
  s_sleep 4
  s_sub_u32 s48, s48, 1
  s_cbranch_scc0 LF_pl16
LF_pl16d:
LF_xs1:
  s_add_u32 s49, s49, 153600
  v_add_u32 v25, s49, v3
  ds_write_b64 v25, v[100:101]
  s_waitcnt lgkmcnt(0)
LF_nxs:
  s_mul_i32 s48, s50, 6144
  s_add_u32 s48, s48, 16384
  v_add_u32 v14, s48, v2
  v_xor_b32 v15, 4096, v14
  v_add_u32 v10, 49152, v8
  v_add_u32 v16, 49152, v14
  v_add_u32 v11, 49152, v9
  v_add_u32 v17, 49152, v15
  v_add_u32 v12, 98304, v8
  v_add_u32 v18, 98304, v14
  v_add_u32 v13, 98304, v9
  v_add_u32 v19, 98304, v15
  v_mov_b32 v20, 1
  v_mov_b32 v26, 0xffff0000
  s_barrier
  s_barrier
  s_cmp_ge_u32 s63, 14
  s_cbranch_scc1 LF_now
  s_lshl_b32 s48, s41, 8
  s_lshl_b32 s49, s15, 7
  s_add_u32 s48, s48, s49
  v_lshlrev_b32 v166, 1, v164
  buffer_load_ushort v28, v166, s[28:31], s48 offen
  buffer_load_ushort v29, v166, s[28:31], s48 offen offset:64
  s_add_u32 m0, s58, 0
  s_add_u32 s48, s56, 65536
  buffer_load_dwordx4 v4, s[24:27], s56 offen lds
  s_add_u32 m0, s58, 1024
  s_add_u32 s49, s56, 128
  buffer_load_dwordx4 v5, s[24:27], s56 offen lds
  s_add_u32 m0, s58, 2048
  s_and_b32 s49, s49, 0xfff
  buffer_load_dwordx4 v4, s[24:27], s48 offen lds
  s_add_u32 m0, s58, 3072
  s_or_b32 s56, s60, s49
  buffer_load_dwordx4 v5, s[24:27], s48 offen lds
  s_add_u32 m0, s58, 24576
  s_add_u32 s48, s56, 65536
  buffer_load_dwordx4 v4, s[24:27], s56 offen lds
  s_add_u32 m0, s58, 25600
  s_add_u32 s49, s56, 128
  buffer_load_dwordx4 v5, s[24:27], s56 offen lds
  s_add_u32 m0, s58, 26624
  s_and_b32 s49, s49, 0xfff
  buffer_load_dwordx4 v4, s[24:27], s48 offen lds
  s_add_u32 m0, s58, 27648
  s_or_b32 s56, s60, s49
  buffer_load_dwordx4 v5, s[24:27], s48 offen lds
LF_now:
  v_mov_b32 v48, 0
  v_mov_b32 v80, 0
  v_mov_b32 v49, 0
  v_mov_b32 v81, 0
  v_mov_b32 v50, 0
  v_mov_b32 v82, 0
  v_mov_b32 v51, 0
  v_mov_b32 v83, 0
  v_mov_b32 v52, 0
  v_mov_b32 v84, 0
  v_mov_b32 v53, 0
  v_mov_b32 v85, 0
  v_mov_b32 v54, 0
  v_mov_b32 v86, 0
  v_mov_b32 v55, 0
  v_mov_b32 v87, 0
  v_mov_b32 v56, 0
  v_mov_b32 v88, 0
  v_mov_b32 v57, 0
  v_mov_b32 v89, 0
  v_mov_b32 v58, 0
  v_mov_b32 v90, 0
  v_mov_b32 v59, 0
  v_mov_b32 v91, 0
  v_mov_b32 v60, 0
  v_mov_b32 v92, 0
  v_mov_b32 v61, 0
  v_mov_b32 v93, 0
  v_mov_b32 v62, 0
  v_mov_b32 v94, 0
  v_mov_b32 v63, 0
  v_mov_b32 v95, 0
  v_add_u32 v25, 1024, v6
LF_sp17:
  ds_read_b32 v30, v25
  s_waitcnt lgkmcnt(0)
  v_cmp_gt_u32 vcc, 1, v30
  s_nop 0
  s_cbranch_vccz LF_sp17d
  s_sleep 2
  s_branch LF_sp17
LF_sp17d:
  s_cmp_ge_u32 s42, 14
  s_cbranch_scc1 LF_nonorm
  ds_read_b128 v[128:131], v27 offset:0
  ds_read_b128 v[132:135], v27 offset:1024
  ds_read_b128 v[136:139], v27 offset:2048
  ds_read_b128 v[140:143], v27 offset:3072
  s_lshl_b32 s51, s47, 13
  s_add_u32 s51, s51, 18219008
  s_add_u32 s50, s51, 4096
  s_cmp_eq_u32 s42, 0
  s_cselect_b32 s48, 0, -1
  s_cselect_b32 s49, 0, 0xffff0000
  v_mov_b32 v124, 0
  v_mov_b32 v125, 0
  v_mov_b32 v126, 0
  v_mov_b32 v127, 0
  s_waitcnt lgkmcnt(2)
  v_and_b32 v128, s48, v128
  v_and_b32 v129, s48, v129
  v_and_b32 v130, s48, v130
  v_and_b32 v131, s48, v131
  v_and_b32 v132, s48, v132
  v_and_b32 v133, s48, v133
  v_and_b32 v134, s48, v134
  v_and_b32 v135, s48, v135
  v_lshlrev_b32 v32, 16, v128
  v_and_b32 v33, v26, v128
  v_pk_add_f32 v[124:125], v[124:125], v[32:33]
  v_pk_fma_f32 v[126:127], v[32:33], v[32:33], v[126:127]
  v_lshlrev_b32 v34, 16, v129
  v_and_b32 v35, v26, v129
  v_pk_add_f32 v[124:125], v[124:125], v[34:35]
  v_pk_fma_f32 v[126:127], v[34:35], v[34:35], v[126:127]
  v_lshlrev_b32 v36, 16, v130
  v_and_b32 v37, v26, v130
  v_pk_add_f32 v[124:125], v[124:125], v[36:37]
  v_pk_fma_f32 v[126:127], v[36:37], v[36:37], v[126:127]
  v_lshlrev_b32 v38, 16, v131
  v_and_b32 v39, v26, v131
  v_pk_add_f32 v[124:125], v[124:125], v[38:39]
  v_pk_fma_f32 v[126:127], v[38:39], v[38:39], v[126:127]
  v_lshlrev_b32 v40, 16, v132
  v_and_b32 v41, v26, v132
  v_pk_add_f32 v[124:125], v[124:125], v[40:41]
  v_pk_fma_f32 v[126:127], v[40:41], v[40:41], v[126:127]
  v_lshlrev_b32 v42, 16, v133
  v_and_b32 v43, v26, v133
  v_pk_add_f32 v[124:125], v[124:125], v[42:43]
  v_pk_fma_f32 v[126:127], v[42:43], v[42:43], v[126:127]
  v_lshlrev_b32 v44, 16, v134
  v_and_b32 v45, v26, v134
  v_pk_add_f32 v[124:125], v[124:125], v[44:45]
  v_pk_fma_f32 v[126:127], v[44:45], v[44:45], v[126:127]
  v_lshlrev_b32 v46, 16, v135
  v_and_b32 v47, v26, v135
  v_pk_add_f32 v[124:125], v[124:125], v[46:47]
  v_pk_fma_f32 v[126:127], v[46:47], v[46:47], v[126:127]
  s_waitcnt lgkmcnt(0)
  v_lshlrev_b32 v64, 16, v136
  v_and_b32 v65, v26, v136
  v_pk_add_f32 v[124:125], v[124:125], v[64:65]
  v_pk_fma_f32 v[126:127], v[64:65], v[64:65], v[126:127]
  v_lshlrev_b32 v66, 16, v137
  v_and_b32 v67, v26, v137
  v_pk_add_f32 v[124:125], v[124:125], v[66:67]
  v_pk_fma_f32 v[126:127], v[66:67], v[66:67], v[126:127]
  v_lshlrev_b32 v68, 16, v138
  v_and_b32 v69, v26, v138
  v_pk_add_f32 v[124:125], v[124:125], v[68:69]
  v_pk_fma_f32 v[126:127], v[68:69], v[68:69], v[126:127]
  v_lshlrev_b32 v70, 16, v139
  v_and_b32 v71, v26, v139
  v_pk_add_f32 v[124:125], v[124:125], v[70:71]
  v_pk_fma_f32 v[126:127], v[70:71], v[70:71], v[126:127]
  v_lshlrev_b32 v72, 16, v140
  v_and_b32 v73, v26, v140
  v_pk_add_f32 v[124:125], v[124:125], v[72:73]
  v_pk_fma_f32 v[126:127], v[72:73], v[72:73], v[126:127]
  v_lshlrev_b32 v74, 16, v141
  v_and_b32 v75, v26, v141
  v_pk_add_f32 v[124:125], v[124:125], v[74:75]
  v_pk_fma_f32 v[126:127], v[74:75], v[74:75], v[126:127]
  v_lshlrev_b32 v76, 16, v142
  v_and_b32 v77, v26, v142
  v_pk_add_f32 v[124:125], v[124:125], v[76:77]
  v_pk_fma_f32 v[126:127], v[76:77], v[76:77], v[126:127]
  v_lshlrev_b32 v78, 16, v143
  v_and_b32 v79, v26, v143
  v_pk_add_f32 v[124:125], v[124:125], v[78:79]
  v_pk_fma_f32 v[126:127], v[78:79], v[78:79], v[126:127]
  v_add_f32 v124, v124, v125
  v_add_f32 v126, v126, v127
  s_lshl_b32 s49, s42, 9
  s_add_u32 s49, s49, s51
  v_permlane32_swap_b32 v124, v126
  s_nop 0
  v_add_f32 v124, v124, v126
  v_mov_b32 v125, v124
  v_mov_b32 v126, v160
  v_mov_b32 v127, v161
  v_permlane32_swap_b32 v124, v125
  s_mov_b32 exec_hi, 0
  buffer_store_dwordx4 v[124:127], v2, s[36:39], s49 offen sc0 sc1
  s_mov_b32 exec_hi, -1
  s_waitcnt vmcnt(0)
  s_cmp_lg_u32 s42, 0
  s_cbranch_scc1 LF_sd
  s_sleep 56
LF_sd:
  s_sleep 22
  s_mov_b32 s48, 0x20000
LF_pl18:
  buffer_load_dwordx4 v[96:99], v2, s[36:39], s51 offen offset:0 sc0 sc1
  buffer_load_dwordx4 v[100:103], v2, s[36:39], s51 offen offset:1024 sc0 sc1
  buffer_load_dwordx4 v[104:107], v2, s[36:39], s51 offen offset:2048 sc0 sc1
  buffer_load_dwordx4 v[108:111], v2, s[36:39], s51 offen offset:3072 sc0 sc1
  buffer_load_dwordx4 v[112:115], v2, s[36:39], s50 offen offset:0 sc0 sc1
  buffer_load_dwordx4 v[116:119], v2, s[36:39], s50 offen offset:1024 sc0 sc1
  buffer_load_dwordx4 v[120:123], v2, s[36:39], s50 offen offset:2048 sc0 sc1
  s_waitcnt vmcnt(6)
  v_cmp_ne_u64 vcc, v[98:99], v[160:161]
  s_nop 0
  s_waitcnt vmcnt(5)
  v_cmp_ne_u64 s[54:55], v[102:103], v[160:161]
  s_nop 0
  s_or_b64 vcc, vcc, s[54:55]
  s_waitcnt vmcnt(4)
  v_cmp_ne_u64 s[54:55], v[106:107], v[160:161]
  s_nop 0
  s_or_b64 vcc, vcc, s[54:55]
  s_waitcnt vmcnt(3)
  v_cmp_ne_u64 s[54:55], v[110:111], v[160:161]
  s_nop 0
  s_or_b64 vcc, vcc, s[54:55]
  s_waitcnt vmcnt(2)
  v_cmp_ne_u64 s[54:55], v[114:115], v[160:161]
  s_nop 0
  s_or_b64 vcc, vcc, s[54:55]
  s_waitcnt vmcnt(1)
  v_cmp_ne_u64 s[54:55], v[118:119], v[160:161]
  s_nop 0
  s_or_b64 vcc, vcc, s[54:55]
  s_waitcnt vmcnt(0)
  v_cmp_ne_u64 s[54:55], v[122:123], v[160:161]
  s_nop 0
  s_or_b64 vcc, vcc, s[54:55]
  s_cbranch_vccz LF_pl18d
  s_sleep 6
  s_sub_u32 s48, s48, 1
  s_cbranch_scc0 LF_pl18
LF_pl18d:
  v_add_f32 v100, v100, v112
  v_add_f32 v101, v101, v113
  v_add_f32 v104, v104, v116
  v_add_f32 v105, v105, v117
  v_add_f32 v108, v108, v120
  v_add_f32 v109, v109, v121
  v_add_f32 v96, v96, v100
  v_add_f32 v97, v97, v101
  v_add_f32 v96, v96, v104
  v_add_f32 v97, v97, v105
  v_add_f32 v96, v96, v108
  v_add_f32 v97, v97, v109
  s_lshl_b32 s49, s42, 1
  s_sub_u32 s48, s49, 1
  v_permlane32_swap_b32 v96, v97
  s_cselect_b32 s48, 27, s48
  v_add_f32 v96, v96, v97
  v_mul_f32 v96, 0x3a97b426, v96
  v_mov_b32 v97, v96
  s_lshl_b32 s50, s48, 9
  s_lshl_b32 s51, s49, 9
  v_permlane32_swap_b32 v96, v97
  s_lshl_b32 s48, s48, 17
  v_fma_f32 v97, -v96, v96, v97
  v_max_f32 v97, 0, v97
  v_add_f32 v97, 0x3727c5ac, v97
  v_rsq_f32 v97, v97
  s_lshl_b32 s49, s49, 17
  v_mul_f32 v96, -v96, v97
  s_lshl_b32 s46, s47, 11
  s_add_u32 s46, s46, 6160384
  s_add_u32 s48, s48, s46
  s_add_u32 s49, s49, s46
  s_lshl3_add_u32 s46, s47, 18907136
  s_add_u32 s50, s50, s46
  s_add_u32 s51, s51, s46
  v_fma_f32 v32, v32, v97, v96
  v_fma_f32 v33, v33, v97, v96
  v_cvt_pk_bf16_f32 v128, v32, v33
  v_fma_f32 v34, v34, v97, v96
  v_fma_f32 v35, v35, v97, v96
  v_cvt_pk_bf16_f32 v129, v34, v35
  v_fma_f32 v36, v36, v97, v96
  v_fma_f32 v37, v37, v97, v96
  v_cvt_pk_bf16_f32 v130, v36, v37
  v_fma_f32 v38, v38, v97, v96
  v_fma_f32 v39, v39, v97, v96
  v_cvt_pk_bf16_f32 v131, v38, v39
  ds_write_b64 v24, v[128:129] offset:0
  ds_write_b64 v24, v[130:131] offset:16
  v_fma_f32 v40, v40, v97, v96
  v_fma_f32 v41, v41, v97, v96
  v_cvt_pk_bf16_f32 v132, v40, v41
  v_fma_f32 v42, v42, v97, v96
  v_fma_f32 v43, v43, v97, v96
  v_cvt_pk_bf16_f32 v133, v42, v43
  v_fma_f32 v44, v44, v97, v96
  v_fma_f32 v45, v45, v97, v96
  v_cvt_pk_bf16_f32 v134, v44, v45
  v_fma_f32 v46, v46, v97, v96
  v_fma_f32 v47, v47, v97, v96
  v_cvt_pk_bf16_f32 v135, v46, v47
  ds_write_b64 v24, v[132:133] offset:32
  ds_write_b64 v24, v[134:135] offset:48
  v_fma_f32 v64, v64, v97, v96
  v_fma_f32 v65, v65, v97, v96
  v_cvt_pk_bf16_f32 v136, v64, v65
  v_fma_f32 v66, v66, v97, v96
  v_fma_f32 v67, v67, v97, v96
  v_cvt_pk_bf16_f32 v137, v66, v67
  v_fma_f32 v68, v68, v97, v96
  v_fma_f32 v69, v69, v97, v96
  v_cvt_pk_bf16_f32 v138, v68, v69
  v_fma_f32 v70, v70, v97, v96
  v_fma_f32 v71, v71, v97, v96
  v_cvt_pk_bf16_f32 v139, v70, v71
  ds_write_b64 v24, v[136:137] offset:2048
  ds_write_b64 v24, v[138:139] offset:2064
  v_fma_f32 v72, v72, v97, v96
  v_fma_f32 v73, v73, v97, v96
  v_cvt_pk_bf16_f32 v140, v72, v73
  v_fma_f32 v74, v74, v97, v96
  v_fma_f32 v75, v75, v97, v96
  v_cvt_pk_bf16_f32 v141, v74, v75
  v_fma_f32 v76, v76, v97, v96
  v_fma_f32 v77, v77, v97, v96
  v_cvt_pk_bf16_f32 v142, v76, v77
  v_fma_f32 v78, v78, v97, v96
  v_fma_f32 v79, v79, v97, v96
  v_cvt_pk_bf16_f32 v143, v78, v79
  ds_write_b64 v24, v[140:141] offset:2080
  ds_write_b64 v24, v[142:143] offset:2096
  s_waitcnt lgkmcnt(0)
  ds_read_b64_tr_b16 v[128:129], v23 offset:0
  ds_read_b64_tr_b16 v[130:131], v23 offset:256
  ds_read_b64_tr_b16 v[132:133], v23 offset:1024
  ds_read_b64_tr_b16 v[134:135], v23 offset:1280
  ds_read_b64_tr_b16 v[136:137], v23 offset:2048
  ds_read_b64_tr_b16 v[138:139], v23 offset:2304
  ds_read_b64_tr_b16 v[140:141], v23 offset:3072
  ds_read_b64_tr_b16 v[142:143], v23 offset:3328
  s_waitcnt lgkmcnt(6)
  buffer_store_dwordx4 v[128:131], v2, s[36:39], s48 offen offset:0 sc0 sc1
  s_waitcnt lgkmcnt(4)
  buffer_store_dwordx4 v[132:135], v2, s[36:39], s48 offen offset:1024 sc0 sc1
  s_waitcnt lgkmcnt(2)
  buffer_store_dwordx4 v[136:139], v2, s[36:39], s49 offen offset:0 sc0 sc1
  s_waitcnt lgkmcnt(0)
  buffer_store_dwordx4 v[140:143], v2, s[36:39], s49 offen offset:1024 sc0 sc1
  v_lshrrev_b32 v166, 0, v1
  v_lshlrev_b32 v166, 16, v166
  s_waitcnt vmcnt(0)
  s_mov_b32 exec_hi, 0
  s_mov_b32 exec_lo, 0x1
  buffer_store_dwordx2 v[160:161], v166, s[36:39], s50 offen sc0 sc1
  s_mov_b64 exec, -1
  v_lshrrev_b32 v166, 0, v1
  v_lshlrev_b32 v166, 16, v166
  s_mov_b32 exec_hi, 0
  s_mov_b32 exec_lo, 0x1
  buffer_store_dwordx2 v[160:161], v166, s[36:39], s51 offen sc0 sc1
  s_mov_b64 exec, -1
LF_nonorm:
  s_cmp_ge_u32 s63, 14
  s_cbranch_scc1 LF_idle
  s_lshl_b32 s47, s41, 2
  s_lshl1_add_u32 s47, s15, s47
LF_sp19:
  ds_read_b32 v30, v25
  s_waitcnt lgkmcnt(0)
  v_cmp_gt_u32 vcc, 2, v30
  s_nop 0
  s_cbranch_vccz LF_sp19d
  s_sleep 2
  s_branch LF_sp19
LF_sp19d:
  s_lshl_b32 s48, s15, 13
  s_lshr_b32 s49, s43, 1
  s_lshl_b32 s49, s49, 11
  s_add_u32 s48, s48, s49
  s_add_u32 s48, s48, 81920
  v_add_u32 v30, s48, v2
  ds_read_b128 v[144:147], v30 offset:0
  ds_read_b128 v[148:151], v30 offset:1024
  ds_read_b128 v[152:155], v30 offset:4096
  ds_read_b128 v[156:159], v30 offset:5120
  s_waitcnt vmcnt(2) lgkmcnt(0)
  v_lshlrev_b32 v28, 16, v28
  v_lshlrev_b32 v29, 16, v29
  v_mov_b32 v32, v28
  v_mov_b32 v64, v29
  v_mov_b32 v33, v28
  v_mov_b32 v65, v29
  v_mov_b32 v34, v28
  v_mov_b32 v66, v29
  v_mov_b32 v35, v28
  v_mov_b32 v67, v29
  v_mov_b32 v36, v28
  v_mov_b32 v68, v29
  v_mov_b32 v37, v28
  v_mov_b32 v69, v29
  v_mov_b32 v38, v28
  v_mov_b32 v70, v29
  v_mov_b32 v39, v28
  v_mov_b32 v71, v29
  v_mov_b32 v40, v28
  v_mov_b32 v72, v29
  v_mov_b32 v41, v28
  v_mov_b32 v73, v29
  v_mov_b32 v42, v28
  v_mov_b32 v74, v29
  v_mov_b32 v43, v28
  v_mov_b32 v75, v29
  v_mov_b32 v44, v28
  v_mov_b32 v76, v29
  v_mov_b32 v45, v28
  v_mov_b32 v77, v29
  v_mov_b32 v46, v28
  v_mov_b32 v78, v29
  v_mov_b32 v47, v28
  v_mov_b32 v79, v29
  s_cmp_lg_u32 s43, 0
  s_cbranch_scc1 LF_gnp
  s_sleep 30
  s_lshl_b32 s49, s63, 10
  s_add_u32 s49, s49, 18907136
  s_mov_b32 s48, 0x20000
LF_pl20:
  buffer_load_dwordx4 v[96:99], v2, s[36:39], s49 offen sc0 sc1
  s_waitcnt vmcnt(0)
  v_cmp_ne_u64 vcc, v[96:97], v[160:161]
  s_nop 0
  v_cmp_ne_u64 s[54:55], v[98:99], v[160:161]
  s_nop 0
  s_or_b64 vcc, vcc, s[54:55]
  s_cbranch_vccz LF_pl20d
  s_cmp_gt_u32 s48, 131072
  s_cselect_b32 s54, 65536, 0
  s_add_u32 s49, s49, s54
  s_sleep 8
  s_sub_u32 s48, s48, 1
  s_cbranch_scc0 LF_pl20
LF_pl20d:
LF_gnp:
  ds_add_u32 v7, v20
  ds_read_b32 v21, v6
  s_mov_b32 s62, 1
  s_waitcnt lgkmcnt(0)
  v_cmp_gt_u32 vcc, s62, v21
  s_nop 0
  s_cbranch_vccz LF_sb21d
LF_sb21:
  s_sleep 2
  ds_read_b32 v21, v6
  s_waitcnt lgkmcnt(0)
  v_cmp_gt_u32 vcc, s62, v21
  s_nop 0
  s_cbranch_vccnz LF_sb21
LF_sb21d:
  s_add_u32 m0, s59, 16384
  s_add_u32 s49, s57, 4096
  buffer_load_dwordx4 v2, s[36:39], s57 offen sc1 lds
  s_and_b32 s49, s49, 0x1ffff
  buffer_load_dwordx4 v2, s[36:39], s57 offen offset:1024 sc1 lds
  s_or_b32 s57, s61, s49
  s_add_u32 m0, s59, 40960
  s_add_u32 s49, s57, 4096
  buffer_load_dwordx4 v2, s[36:39], s57 offen sc1 lds
  s_and_b32 s49, s49, 0x1ffff
  buffer_load_dwordx4 v2, s[36:39], s57 offen offset:1024 sc1 lds
  s_or_b32 s57, s61, s49
  s_add_u32 m0, s58, 49152
  s_add_u32 s48, s56, 65536
  buffer_load_dwordx4 v4, s[24:27], s56 offen lds
  s_add_u32 m0, s58, 50176
  s_add_u32 s49, s56, 128
  buffer_load_dwordx4 v5, s[24:27], s56 offen lds
  s_add_u32 m0, s58, 51200
  s_and_b32 s49, s49, 0xfff
  buffer_load_dwordx4 v4, s[24:27], s48 offen lds
  s_add_u32 m0, s58, 52224
  s_or_b32 s56, s60, s49
  buffer_load_dwordx4 v5, s[24:27], s48 offen lds
  s_add_u32 m0, s59, 65536
  s_add_u32 s49, s57, 4096
  buffer_load_dwordx4 v2, s[36:39], s57 offen sc1 lds
  s_and_b32 s49, s49, 0x1ffff
  buffer_load_dwordx4 v2, s[36:39], s57 offen offset:1024 sc1 lds
  s_or_b32 s57, s61, s49
  s_add_u32 m0, s58, 73728
  s_add_u32 s48, s56, 65536
  buffer_load_dwordx4 v4, s[24:27], s56 offen lds
  s_add_u32 m0, s58, 74752
  s_add_u32 s49, s56, 128
  buffer_load_dwordx4 v5, s[24:27], s56 offen lds
  s_add_u32 m0, s58, 75776
  s_and_b32 s49, s49, 0xfff
  buffer_load_dwordx4 v4, s[24:27], s48 offen lds
  s_add_u32 m0, s58, 76800
  s_or_b32 s56, s60, s49
  buffer_load_dwordx4 v5, s[24:27], s48 offen lds
  s_add_u32 m0, s59, 90112
  s_add_u32 s49, s57, 4096
  buffer_load_dwordx4 v2, s[36:39], s57 offen sc1 lds
  s_and_b32 s49, s49, 0x1ffff
  buffer_load_dwordx4 v2, s[36:39], s57 offen offset:1024 sc1 lds
  s_or_b32 s57, s61, s49
LF_sp22:
  ds_read_b32 v30, v31
  s_waitcnt lgkmcnt(0)
  v_cmp_gt_u32 vcc, 5, v30
  s_nop 0
  s_cbranch_vccz LF_sp22d
  s_sleep 2
  s_branch LF_sp22
LF_sp22d:
  s_waitcnt vmcnt(12)
  ds_add_u32 v7, v20
  ds_read_b32 v21, v6
  s_mov_b32 s62, 2
  s_setprio 3
  s_waitcnt lgkmcnt(0)
  v_cmp_gt_u32 vcc, s62, v21
  s_nop 0
  s_cbranch_vccz LF_sb23d
LF_sb23:
  ds_read_b32 v21, v6
  s_waitcnt lgkmcnt(0)
  v_cmp_gt_u32 vcc, s62, v21
  s_nop 0
  s_cbranch_vccnz LF_sb23
LF_sb23d:
  s_setprio 2
  s_mov_b32 s62, 1
  ds_read_b128 v[96:99], v8 offset:0
  ds_read_b128 v[104:107], v14 offset:0
  ds_read_b128 v[100:103], v8 offset:4096
  ds_read_b128 v[108:111], v15 offset:0
  s_mov_b32 s46, 4
.p2align 6
LF_gloop:
  s_waitcnt lgkmcnt(2)
  v_mfma_f32_32x32x16_bf16 v[32:47], v[104:107], v[96:99], v[32:47]
  ds_read_b128 v[112:115], v9 offset:0
  ds_read_b128 v[120:123], v14 offset:1024
  s_waitcnt lgkmcnt(3)
  v_mfma_f32_32x32x16_bf16 v[64:79], v[104:107], v[100:103], v[64:79]
  ds_read_b128 v[116:119], v9 offset:4096
  ds_read_b128 v[124:127], v15 offset:1024
  s_waitcnt lgkmcnt(4)
  v_mfma_f32_32x32x16_bf16 v[48:63], v[108:111], v[96:99], v[48:63]
  s_add_u32 m0, s58, 98304
  s_add_u32 s48, s56, 65536
  buffer_load_dwordx4 v4, s[24:27], s56 offen lds
  ds_read_b32 v21, v6
  v_mfma_f32_32x32x16_bf16 v[80:95], v[108:111], v[100:103], v[80:95]
  s_add_u32 m0, s58, 99328
  s_add_u32 s49, s56, 128
  buffer_load_dwordx4 v5, s[24:27], s56 offen lds
  s_add_u32 s62, s62, 1
  s_setprio 3
  s_waitcnt lgkmcnt(0)
  v_cmp_gt_u32 vcc, s62, v21
  s_nop 0
  s_cbranch_vccz LF_sb24d
LF_sb24:
  ds_read_b32 v21, v6
  s_waitcnt lgkmcnt(0)
  v_cmp_gt_u32 vcc, s62, v21
  s_nop 0
  s_cbranch_vccnz LF_sb24
LF_sb24d:
  s_setprio 2
  v_mfma_f32_32x32x16_bf16 v[32:47], v[120:123], v[112:115], v[32:47]
  s_waitcnt vmcnt(8)
  ds_add_u32 v7, v20
  ds_read_b128 v[96:99], v8 offset:24576
  ds_read_b128 v[104:107], v14 offset:24576
  v_mfma_f32_32x32x16_bf16 v[64:79], v[120:123], v[116:119], v[64:79]
  ds_read_b128 v[100:103], v8 offset:28672
  ds_read_b128 v[108:111], v15 offset:24576
  s_add_u32 m0, s58, 100352
  s_and_b32 s49, s49, 0xfff
  buffer_load_dwordx4 v4, s[24:27], s48 offen lds
  v_mfma_f32_32x32x16_bf16 v[48:63], v[124:127], v[112:115], v[48:63]
  s_add_u32 m0, s58, 101376
  s_or_b32 s56, s60, s49
  buffer_load_dwordx4 v5, s[24:27], s48 offen lds
  s_add_u32 m0, s59, 114688
  s_add_u32 s49, s57, 4096
  buffer_load_dwordx4 v2, s[36:39], s57 offen sc1 lds
  v_mfma_f32_32x32x16_bf16 v[80:95], v[124:127], v[116:119], v[80:95]
  s_and_b32 s49, s49, 0x1ffff
  buffer_load_dwordx4 v2, s[36:39], s57 offen offset:1024 sc1 lds
  s_or_b32 s57, s61, s49
  s_waitcnt lgkmcnt(2)
  v_mfma_f32_32x32x16_bf16 v[32:47], v[104:107], v[96:99], v[32:47]
  ds_read_b128 v[112:115], v9 offset:24576
  ds_read_b128 v[120:123], v14 offset:25600
  s_waitcnt lgkmcnt(3)
  v_mfma_f32_32x32x16_bf16 v[64:79], v[104:107], v[100:103], v[64:79]
  ds_read_b128 v[116:119], v9 offset:28672
  ds_read_b128 v[124:127], v15 offset:25600
  s_waitcnt lgkmcnt(4)
  v_mfma_f32_32x32x16_bf16 v[48:63], v[108:111], v[96:99], v[48:63]
  s_add_u32 m0, s58, 122880
  s_add_u32 s48, s56, 65536
  buffer_load_dwordx4 v4, s[24:27], s56 offen lds
  ds_read_b32 v21, v6
  v_mfma_f32_32x32x16_bf16 v[80:95], v[108:111], v[100:103], v[80:95]
  s_add_u32 m0, s58, 123904
  s_add_u32 s49, s56, 128
  buffer_load_dwordx4 v5, s[24:27], s56 offen lds
  s_add_u32 s62, s62, 1
  s_setprio 3
  s_waitcnt lgkmcnt(0)
  v_cmp_gt_u32 vcc, s62, v21
  s_nop 0
  s_cbranch_vccz LF_sb25d
LF_sb25:
  ds_read_b32 v21, v6
  s_waitcnt lgkmcnt(0)
  v_cmp_gt_u32 vcc, s62, v21
  s_nop 0
  s_cbranch_vccnz LF_sb25
LF_sb25d:
  s_setprio 2
  v_mfma_f32_32x32x16_bf16 v[32:47], v[120:123], v[112:115], v[32:47]
  s_waitcnt vmcnt(8)
  ds_add_u32 v7, v20
  ds_read_b128 v[96:99], v10 offset:0
  ds_read_b128 v[104:107], v16 offset:0
  v_mfma_f32_32x32x16_bf16 v[64:79], v[120:123], v[116:119], v[64:79]
  ds_read_b128 v[100:103], v10 offset:4096
  ds_read_b128 v[108:111], v17 offset:0
  s_add_u32 m0, s58, 124928
  s_and_b32 s49, s49, 0xfff
  buffer_load_dwordx4 v4, s[24:27], s48 offen lds
  v_mfma_f32_32x32x16_bf16 v[48:63], v[124:127], v[112:115], v[48:63]
  s_add_u32 m0, s58, 125952
  s_or_b32 s56, s60, s49
  buffer_load_dwordx4 v5, s[24:27], s48 offen lds
  s_add_u32 m0, s59, 139264
  s_add_u32 s49, s57, 4096
  buffer_load_dwordx4 v2, s[36:39], s57 offen sc1 lds
  v_mfma_f32_32x32x16_bf16 v[80:95], v[124:127], v[116:119], v[80:95]
  s_and_b32 s49, s49, 0x1ffff
  buffer_load_dwordx4 v2, s[36:39], s57 offen offset:1024 sc1 lds
  s_or_b32 s57, s61, s49
  s_waitcnt lgkmcnt(2)
  v_mfma_f32_32x32x16_bf16 v[32:47], v[104:107], v[96:99], v[32:47]
  ds_read_b128 v[112:115], v11 offset:0
  ds_read_b128 v[120:123], v16 offset:1024
  s_waitcnt lgkmcnt(3)
  v_mfma_f32_32x32x16_bf16 v[64:79], v[104:107], v[100:103], v[64:79]
  ds_read_b128 v[116:119], v11 offset:4096
  ds_read_b128 v[124:127], v17 offset:1024
  s_waitcnt lgkmcnt(4)
  v_mfma_f32_32x32x16_bf16 v[48:63], v[108:111], v[96:99], v[48:63]
  s_add_u32 m0, s58, 0
  s_add_u32 s48, s56, 65536
  buffer_load_dwordx4 v4, s[24:27], s56 offen lds
  ds_read_b32 v21, v6
  v_mfma_f32_32x32x16_bf16 v[80:95], v[108:111], v[100:103], v[80:95]
  s_add_u32 m0, s58, 1024
  s_add_u32 s49, s56, 128
  buffer_load_dwordx4 v5, s[24:27], s56 offen lds
  s_add_u32 s62, s62, 1
  s_setprio 3
  s_waitcnt lgkmcnt(0)
  v_cmp_gt_u32 vcc, s62, v21
  s_nop 0
  s_cbranch_vccz LF_sb26d
LF_sb26:
  ds_read_b32 v21, v6
  s_waitcnt lgkmcnt(0)
  v_cmp_gt_u32 vcc, s62, v21
  s_nop 0
  s_cbranch_vccnz LF_sb26
LF_sb26d:
  s_setprio 2
  v_mfma_f32_32x32x16_bf16 v[32:47], v[120:123], v[112:115], v[32:47]
  s_waitcnt vmcnt(8)
  ds_add_u32 v7, v20
  ds_read_b128 v[96:99], v10 offset:24576
  ds_read_b128 v[104:107], v16 offset:24576
  v_mfma_f32_32x32x16_bf16 v[64:79], v[120:123], v[116:119], v[64:79]
  ds_read_b128 v[100:103], v10 offset:28672
  ds_read_b128 v[108:111], v17 offset:24576
  s_add_u32 m0, s58, 2048
  s_and_b32 s49, s49, 0xfff
  buffer_load_dwordx4 v4, s[24:27], s48 offen lds
  v_mfma_f32_32x32x16_bf16 v[48:63], v[124:127], v[112:115], v[48:63]
  s_add_u32 m0, s58, 3072
  s_or_b32 s56, s60, s49
  buffer_load_dwordx4 v5, s[24:27], s48 offen lds
  s_add_u32 m0, s59, 16384
  s_add_u32 s49, s57, 4096
  buffer_load_dwordx4 v2, s[36:39], s57 offen sc1 lds
  v_mfma_f32_32x32x16_bf16 v[80:95], v[124:127], v[116:119], v[80:95]
  s_and_b32 s49, s49, 0x1ffff
  buffer_load_dwordx4 v2, s[36:39], s57 offen offset:1024 sc1 lds
  s_or_b32 s57, s61, s49
  s_waitcnt lgkmcnt(2)
  v_mfma_f32_32x32x16_bf16 v[32:47], v[104:107], v[96:99], v[32:47]
  ds_read_b128 v[112:115], v11 offset:24576
  ds_read_b128 v[120:123], v16 offset:25600
  s_waitcnt lgkmcnt(3)
  v_mfma_f32_32x32x16_bf16 v[64:79], v[104:107], v[100:103], v[64:79]
  ds_read_b128 v[116:119], v11 offset:28672
  ds_read_b128 v[124:127], v17 offset:25600
  s_waitcnt lgkmcnt(4)
  v_mfma_f32_32x32x16_bf16 v[48:63], v[108:111], v[96:99], v[48:63]
  s_add_u32 m0, s58, 24576
  s_add_u32 s48, s56, 65536
  buffer_load_dwordx4 v4, s[24:27], s56 offen lds
  ds_read_b32 v21, v6
  v_mfma_f32_32x32x16_bf16 v[80:95], v[108:111], v[100:103], v[80:95]
  s_add_u32 m0, s58, 25600
  s_add_u32 s49, s56, 128
  buffer_load_dwordx4 v5, s[24:27], s56 offen lds
  s_add_u32 s62, s62, 1
  s_setprio 3
  s_waitcnt lgkmcnt(0)
  v_cmp_gt_u32 vcc, s62, v21
  s_nop 0
  s_cbranch_vccz LF_sb27d
LF_sb27:
  ds_read_b32 v21, v6
  s_waitcnt lgkmcnt(0)
  v_cmp_gt_u32 vcc, s62, v21
  s_nop 0
  s_cbranch_vccnz LF_sb27
LF_sb27d:
  s_setprio 2
  v_mfma_f32_32x32x16_bf16 v[32:47], v[120:123], v[112:115], v[32:47]
  s_waitcnt vmcnt(8)
  ds_add_u32 v7, v20
  ds_read_b128 v[96:99], v12 offset:0
  ds_read_b128 v[104:107], v18 offset:0
  v_mfma_f32_32x32x16_bf16 v[64:79], v[120:123], v[116:119], v[64:79]
  ds_read_b128 v[100:103], v12 offset:4096
  ds_read_b128 v[108:111], v19 offset:0
  s_add_u32 m0, s58, 26624
  s_and_b32 s49, s49, 0xfff
  buffer_load_dwordx4 v4, s[24:27], s48 offen lds
  v_mfma_f32_32x32x16_bf16 v[48:63], v[124:127], v[112:115], v[48:63]
  s_add_u32 m0, s58, 27648
  s_or_b32 s56, s60, s49
  buffer_load_dwordx4 v5, s[24:27], s48 offen lds
  s_add_u32 m0, s59, 40960
  s_add_u32 s49, s57, 4096
  buffer_load_dwordx4 v2, s[36:39], s57 offen sc1 lds
  v_mfma_f32_32x32x16_bf16 v[80:95], v[124:127], v[116:119], v[80:95]
  s_and_b32 s49, s49, 0x1ffff
  buffer_load_dwordx4 v2, s[36:39], s57 offen offset:1024 sc1 lds
  s_or_b32 s57, s61, s49
  s_waitcnt lgkmcnt(2)
  v_mfma_f32_32x32x16_bf16 v[32:47], v[104:107], v[96:99], v[32:47]
  ds_read_b128 v[112:115], v13 offset:0
  ds_read_b128 v[120:123], v18 offset:1024
  s_waitcnt lgkmcnt(3)
  v_mfma_f32_32x32x16_bf16 v[64:79], v[104:107], v[100:103], v[64:79]
  ds_read_b128 v[116:119], v13 offset:4096
  ds_read_b128 v[124:127], v19 offset:1024
  s_waitcnt lgkmcnt(4)
  v_mfma_f32_32x32x16_bf16 v[48:63], v[108:111], v[96:99], v[48:63]
  s_add_u32 m0, s58, 49152
  s_add_u32 s48, s56, 65536
  buffer_load_dwordx4 v4, s[24:27], s56 offen lds
  ds_read_b32 v21, v6
  v_mfma_f32_32x32x16_bf16 v[80:95], v[108:111], v[100:103], v[80:95]
  s_add_u32 m0, s58, 50176
  s_add_u32 s49, s56, 128
  buffer_load_dwordx4 v5, s[24:27], s56 offen lds
  s_add_u32 s62, s62, 1
  s_setprio 3
  s_waitcnt lgkmcnt(0)
  v_cmp_gt_u32 vcc, s62, v21
  s_nop 0
  s_cbranch_vccz LF_sb28d
LF_sb28:
  ds_read_b32 v21, v6
  s_waitcnt lgkmcnt(0)
  v_cmp_gt_u32 vcc, s62, v21
  s_nop 0
  s_cbranch_vccnz LF_sb28
LF_sb28d:
  s_setprio 2
  v_mfma_f32_32x32x16_bf16 v[32:47], v[120:123], v[112:115], v[32:47]
  s_waitcnt vmcnt(8)
  ds_add_u32 v7, v20
  ds_read_b128 v[96:99], v12 offset:24576
  ds_read_b128 v[104:107], v18 offset:24576
  v_mfma_f32_32x32x16_bf16 v[64:79], v[120:123], v[116:119], v[64:79]
  ds_read_b128 v[100:103], v12 offset:28672
  ds_read_b128 v[108:111], v19 offset:24576
  s_add_u32 m0, s58, 51200
  s_and_b32 s49, s49, 0xfff
  buffer_load_dwordx4 v4, s[24:27], s48 offen lds
  v_mfma_f32_32x32x16_bf16 v[48:63], v[124:127], v[112:115], v[48:63]
  s_add_u32 m0, s58, 52224
  s_or_b32 s56, s60, s49
  buffer_load_dwordx4 v5, s[24:27], s48 offen lds
  s_add_u32 m0, s59, 65536
  s_add_u32 s49, s57, 4096
  buffer_load_dwordx4 v2, s[36:39], s57 offen sc1 lds
  v_mfma_f32_32x32x16_bf16 v[80:95], v[124:127], v[116:119], v[80:95]
  s_and_b32 s49, s49, 0x1ffff
  buffer_load_dwordx4 v2, s[36:39], s57 offen offset:1024 sc1 lds
  s_or_b32 s57, s61, s49
  s_waitcnt lgkmcnt(2)
  v_mfma_f32_32x32x16_bf16 v[32:47], v[104:107], v[96:99], v[32:47]
  ds_read_b128 v[112:115], v13 offset:24576
  ds_read_b128 v[120:123], v18 offset:25600
  s_waitcnt lgkmcnt(3)
  v_mfma_f32_32x32x16_bf16 v[64:79], v[104:107], v[100:103], v[64:79]
  ds_read_b128 v[116:119], v13 offset:28672
  ds_read_b128 v[124:127], v19 offset:25600
  s_waitcnt lgkmcnt(4)
  v_mfma_f32_32x32x16_bf16 v[48:63], v[108:111], v[96:99], v[48:63]
  s_add_u32 m0, s58, 73728
  s_add_u32 s48, s56, 65536
  buffer_load_dwordx4 v4, s[24:27], s56 offen lds
  ds_read_b32 v21, v6
  v_mfma_f32_32x32x16_bf16 v[80:95], v[108:111], v[100:103], v[80:95]
  s_add_u32 m0, s58, 74752
  s_add_u32 s49, s56, 128
  buffer_load_dwordx4 v5, s[24:27], s56 offen lds
  s_add_u32 s62, s62, 1
  s_setprio 3
  s_waitcnt lgkmcnt(0)
  v_cmp_gt_u32 vcc, s62, v21
  s_nop 0
  s_cbranch_vccz LF_sb29d
LF_sb29:
  ds_read_b32 v21, v6
  s_waitcnt lgkmcnt(0)
  v_cmp_gt_u32 vcc, s62, v21
  s_nop 0
  s_cbranch_vccnz LF_sb29
LF_sb29d:
  s_setprio 2
  v_mfma_f32_32x32x16_bf16 v[32:47], v[120:123], v[112:115], v[32:47]
  s_waitcnt vmcnt(8)
  ds_add_u32 v7, v20
  ds_read_b128 v[96:99], v8 offset:0
  ds_read_b128 v[104:107], v14 offset:0
  v_mfma_f32_32x32x16_bf16 v[64:79], v[120:123], v[116:119], v[64:79]
  ds_read_b128 v[100:103], v8 offset:4096
  ds_read_b128 v[108:111], v15 offset:0
  s_add_u32 m0, s58, 75776
  s_and_b32 s49, s49, 0xfff
  buffer_load_dwordx4 v4, s[24:27], s48 offen lds
  v_mfma_f32_32x32x16_bf16 v[48:63], v[124:127], v[112:115], v[48:63]
  s_add_u32 m0, s58, 76800
  s_or_b32 s56, s60, s49
  buffer_load_dwordx4 v5, s[24:27], s48 offen lds
  s_add_u32 m0, s59, 90112
  s_add_u32 s49, s57, 4096
  buffer_load_dwordx4 v2, s[36:39], s57 offen sc1 lds
  v_mfma_f32_32x32x16_bf16 v[80:95], v[124:127], v[116:119], v[80:95]
  s_and_b32 s49, s49, 0x1ffff
  buffer_load_dwordx4 v2, s[36:39], s57 offen offset:1024 sc1 lds
  s_or_b32 s57, s61, s49
  s_sub_u32 s46, s46, 1
  s_cmp_lg_u32 s46, 0
  s_cbranch_scc1 LF_gloop
  s_waitcnt lgkmcnt(2)
  v_mfma_f32_32x32x16_bf16 v[32:47], v[104:107], v[96:99], v[32:47]
  ds_read_b128 v[112:115], v9 offset:0
  ds_read_b128 v[120:123], v14 offset:1024
  s_waitcnt lgkmcnt(3)
  v_mfma_f32_32x32x16_bf16 v[64:79], v[104:107], v[100:103], v[64:79]
  ds_read_b128 v[116:119], v9 offset:4096
  ds_read_b128 v[124:127], v15 offset:1024
  s_waitcnt lgkmcnt(4)
  v_mfma_f32_32x32x16_bf16 v[48:63], v[108:111], v[96:99], v[48:63]
  s_add_u32 m0, s58, 98304
  s_add_u32 s48, s56, 65536
  buffer_load_dwordx4 v4, s[24:27], s56 offen lds
  ds_read_b32 v21, v6
  v_mfma_f32_32x32x16_bf16 v[80:95], v[108:111], v[100:103], v[80:95]
  s_add_u32 m0, s58, 99328
  s_add_u32 s49, s56, 128
  buffer_load_dwordx4 v5, s[24:27], s56 offen lds
  s_add_u32 s62, s62, 1
  s_setprio 3
  s_waitcnt lgkmcnt(0)
  v_cmp_gt_u32 vcc, s62, v21
  s_nop 0
  s_cbranch_vccz LF_sb30d
LF_sb30:
  ds_read_b32 v21, v6
  s_waitcnt lgkmcnt(0)
  v_cmp_gt_u32 vcc, s62, v21
  s_nop 0
  s_cbranch_vccnz LF_sb30
LF_sb30d:
  s_setprio 2
  v_mfma_f32_32x32x16_bf16 v[32:47], v[120:123], v[112:115], v[32:47]
  s_waitcnt vmcnt(8)
  ds_add_u32 v7, v20
  ds_read_b128 v[96:99], v8 offset:24576
  ds_read_b128 v[104:107], v14 offset:24576
  v_mfma_f32_32x32x16_bf16 v[64:79], v[120:123], v[116:119], v[64:79]
  ds_read_b128 v[100:103], v8 offset:28672
  ds_read_b128 v[108:111], v15 offset:24576
  s_add_u32 m0, s58, 100352
  s_and_b32 s49, s49, 0xfff
  buffer_load_dwordx4 v4, s[24:27], s48 offen lds
  v_mfma_f32_32x32x16_bf16 v[48:63], v[124:127], v[112:115], v[48:63]
  s_add_u32 m0, s58, 101376
  s_or_b32 s56, s60, s49
  buffer_load_dwordx4 v5, s[24:27], s48 offen lds
  s_add_u32 m0, s59, 114688
  s_add_u32 s49, s57, 4096
  buffer_load_dwordx4 v2, s[36:39], s57 offen sc1 lds
  v_mfma_f32_32x32x16_bf16 v[80:95], v[124:127], v[116:119], v[80:95]
  s_and_b32 s49, s49, 0x1ffff
  buffer_load_dwordx4 v2, s[36:39], s57 offen offset:1024 sc1 lds
  s_or_b32 s57, s61, s49
  s_waitcnt lgkmcnt(2)
  v_mfma_f32_32x32x16_bf16 v[32:47], v[104:107], v[96:99], v[32:47]
  ds_read_b128 v[112:115], v9 offset:24576
  ds_read_b128 v[120:123], v14 offset:25600
  s_waitcnt lgkmcnt(3)
  v_mfma_f32_32x32x16_bf16 v[64:79], v[104:107], v[100:103], v[64:79]
  ds_read_b128 v[116:119], v9 offset:28672
  ds_read_b128 v[124:127], v15 offset:25600
  s_waitcnt lgkmcnt(4)
  v_mfma_f32_32x32x16_bf16 v[48:63], v[108:111], v[96:99], v[48:63]
  s_add_u32 m0, s58, 122880
  s_add_u32 s48, s56, 65536
  buffer_load_dwordx4 v4, s[24:27], s56 offen lds
  ds_read_b32 v21, v6
  v_mfma_f32_32x32x16_bf16 v[80:95], v[108:111], v[100:103], v[80:95]
  s_add_u32 m0, s58, 123904
  s_add_u32 s49, s56, 128
  buffer_load_dwordx4 v5, s[24:27], s56 offen lds
  s_add_u32 s62, s62, 1
  s_setprio 3
  s_waitcnt lgkmcnt(0)
  v_cmp_gt_u32 vcc, s62, v21
  s_nop 0
  s_cbranch_vccz LF_sb31d
LF_sb31:
  ds_read_b32 v21, v6
  s_waitcnt lgkmcnt(0)
  v_cmp_gt_u32 vcc, s62, v21
  s_nop 0
  s_cbranch_vccnz LF_sb31
LF_sb31d:
  s_setprio 2
  v_mfma_f32_32x32x16_bf16 v[32:47], v[120:123], v[112:115], v[32:47]
  s_waitcnt vmcnt(8)
  ds_add_u32 v7, v20
  ds_read_b128 v[96:99], v10 offset:0
  ds_read_b128 v[104:107], v16 offset:0
  v_mfma_f32_32x32x16_bf16 v[64:79], v[120:123], v[116:119], v[64:79]
  ds_read_b128 v[100:103], v10 offset:4096
  ds_read_b128 v[108:111], v17 offset:0
  s_add_u32 m0, s58, 124928
  s_and_b32 s49, s49, 0xfff
  buffer_load_dwordx4 v4, s[24:27], s48 offen lds
  v_mfma_f32_32x32x16_bf16 v[48:63], v[124:127], v[112:115], v[48:63]
  s_add_u32 m0, s58, 125952
  s_or_b32 s56, s60, s49
  buffer_load_dwordx4 v5, s[24:27], s48 offen lds
  s_add_u32 m0, s59, 139264
  s_add_u32 s49, s57, 4096
  buffer_load_dwordx4 v2, s[36:39], s57 offen sc1 lds
  v_mfma_f32_32x32x16_bf16 v[80:95], v[124:127], v[116:119], v[80:95]
  s_and_b32 s49, s49, 0x1ffff
  buffer_load_dwordx4 v2, s[36:39], s57 offen offset:1024 sc1 lds
  s_or_b32 s57, s61, s49
  s_waitcnt lgkmcnt(2)
  v_mfma_f32_32x32x16_bf16 v[32:47], v[104:107], v[96:99], v[32:47]
  ds_read_b128 v[112:115], v11 offset:0
  ds_read_b128 v[120:123], v16 offset:1024
  s_waitcnt lgkmcnt(3)
  v_mfma_f32_32x32x16_bf16 v[64:79], v[104:107], v[100:103], v[64:79]
  ds_read_b128 v[116:119], v11 offset:4096
  ds_read_b128 v[124:127], v17 offset:1024
  s_waitcnt lgkmcnt(4)
  v_mfma_f32_32x32x16_bf16 v[48:63], v[108:111], v[96:99], v[48:63]
  s_add_u32 m0, s58, 0
  s_add_u32 s48, s56, 65536
  buffer_load_dwordx4 v4, s[24:27], s56 offen lds
  ds_read_b32 v21, v6
  v_mfma_f32_32x32x16_bf16 v[80:95], v[108:111], v[100:103], v[80:95]
  s_add_u32 m0, s58, 1024
  s_add_u32 s49, s56, 128
  buffer_load_dwordx4 v5, s[24:27], s56 offen lds
  s_add_u32 s62, s62, 1
  s_setprio 3
  s_waitcnt lgkmcnt(0)
  v_cmp_gt_u32 vcc, s62, v21
  s_nop 0
  s_cbranch_vccz LF_sb32d
LF_sb32:
  ds_read_b32 v21, v6
  s_waitcnt lgkmcnt(0)
  v_cmp_gt_u32 vcc, s62, v21
  s_nop 0
  s_cbranch_vccnz LF_sb32
LF_sb32d:
  s_setprio 2
  v_mfma_f32_32x32x16_bf16 v[32:47], v[120:123], v[112:115], v[32:47]
  s_waitcnt vmcnt(8)
  ds_add_u32 v7, v20
  ds_read_b128 v[96:99], v10 offset:24576
  ds_read_b128 v[104:107], v16 offset:24576
  v_mfma_f32_32x32x16_bf16 v[64:79], v[120:123], v[116:119], v[64:79]
  ds_read_b128 v[100:103], v10 offset:28672
  ds_read_b128 v[108:111], v17 offset:24576
  s_add_u32 m0, s58, 2048
  s_and_b32 s49, s49, 0xfff
  buffer_load_dwordx4 v4, s[24:27], s48 offen lds
  v_mfma_f32_32x32x16_bf16 v[48:63], v[124:127], v[112:115], v[48:63]
  s_add_u32 m0, s58, 3072
  s_or_b32 s56, s60, s49
  buffer_load_dwordx4 v5, s[24:27], s48 offen lds
  s_add_u32 m0, s59, 16384
  s_add_u32 s49, s57, 4096
  buffer_load_dwordx4 v2, s[36:39], s57 offen sc1 lds
  v_mfma_f32_32x32x16_bf16 v[80:95], v[124:127], v[116:119], v[80:95]
  s_and_b32 s49, s49, 0x1ffff
  buffer_load_dwordx4 v2, s[36:39], s57 offen offset:1024 sc1 lds
  s_or_b32 s57, s61, s49
  s_waitcnt lgkmcnt(2)
  v_mfma_f32_32x32x16_bf16 v[32:47], v[104:107], v[96:99], v[32:47]
  ds_read_b128 v[112:115], v11 offset:24576
  ds_read_b128 v[120:123], v16 offset:25600
  s_waitcnt lgkmcnt(3)
  v_mfma_f32_32x32x16_bf16 v[64:79], v[104:107], v[100:103], v[64:79]
  ds_read_b128 v[116:119], v11 offset:28672
  ds_read_b128 v[124:127], v17 offset:25600
  s_waitcnt lgkmcnt(4)
  v_mfma_f32_32x32x16_bf16 v[48:63], v[108:111], v[96:99], v[48:63]
  s_add_u32 m0, s58, 24576
  s_add_u32 s48, s56, 65536
  buffer_load_dwordx4 v4, s[24:27], s56 offen lds
  ds_read_b32 v21, v6
  v_mfma_f32_32x32x16_bf16 v[80:95], v[108:111], v[100:103], v[80:95]
  s_add_u32 m0, s58, 25600
  s_add_u32 s49, s56, 128
  buffer_load_dwordx4 v5, s[24:27], s56 offen lds
  s_add_u32 s62, s62, 1
  s_setprio 3
  s_waitcnt lgkmcnt(0)
  v_cmp_gt_u32 vcc, s62, v21
  s_nop 0
  s_cbranch_vccz LF_sb33d
LF_sb33:
  ds_read_b32 v21, v6
  s_waitcnt lgkmcnt(0)
  v_cmp_gt_u32 vcc, s62, v21
  s_nop 0
  s_cbranch_vccnz LF_sb33
LF_sb33d:
  s_setprio 2
  v_mfma_f32_32x32x16_bf16 v[32:47], v[120:123], v[112:115], v[32:47]
  s_waitcnt vmcnt(8)
  ds_add_u32 v7, v20
  ds_read_b128 v[96:99], v12 offset:0
  ds_read_b128 v[104:107], v18 offset:0
  v_mfma_f32_32x32x16_bf16 v[64:79], v[120:123], v[116:119], v[64:79]
  ds_read_b128 v[100:103], v12 offset:4096
  ds_read_b128 v[108:111], v19 offset:0
  s_add_u32 m0, s58, 26624
  s_and_b32 s49, s49, 0xfff
  buffer_load_dwordx4 v4, s[24:27], s48 offen lds
  v_mfma_f32_32x32x16_bf16 v[48:63], v[124:127], v[112:115], v[48:63]
  s_add_u32 m0, s58, 27648
  s_or_b32 s56, s60, s49
  buffer_load_dwordx4 v5, s[24:27], s48 offen lds
  s_add_u32 m0, s59, 40960
  s_add_u32 s49, s57, 4096
  buffer_load_dwordx4 v2, s[36:39], s57 offen sc1 lds
  v_mfma_f32_32x32x16_bf16 v[80:95], v[124:127], v[116:119], v[80:95]
  s_and_b32 s49, s49, 0x1ffff
  buffer_load_dwordx4 v2, s[36:39], s57 offen offset:1024 sc1 lds
  s_or_b32 s57, s61, s49
  s_waitcnt lgkmcnt(2)
  v_mfma_f32_32x32x16_bf16 v[32:47], v[104:107], v[96:99], v[32:47]
  ds_read_b128 v[112:115], v13 offset:0
  ds_read_b128 v[120:123], v18 offset:1024
  s_waitcnt lgkmcnt(3)
  v_mfma_f32_32x32x16_bf16 v[64:79], v[104:107], v[100:103], v[64:79]
  ds_read_b128 v[116:119], v13 offset:4096
  ds_read_b128 v[124:127], v19 offset:1024
  s_waitcnt lgkmcnt(4)
  v_mfma_f32_32x32x16_bf16 v[48:63], v[108:111], v[96:99], v[48:63]
  ds_read_b32 v21, v6
  v_mfma_f32_32x32x16_bf16 v[80:95], v[108:111], v[100:103], v[80:95]
  s_add_u32 s62, s62, 1
  s_setprio 3
  s_waitcnt lgkmcnt(0)
  v_cmp_gt_u32 vcc, s62, v21
  s_nop 0
  s_cbranch_vccz LF_sb34d
LF_sb34:
  ds_read_b32 v21, v6
  s_waitcnt lgkmcnt(0)
  v_cmp_gt_u32 vcc, s62, v21
  s_nop 0
  s_cbranch_vccnz LF_sb34
LF_sb34d:
  s_setprio 2
  v_mfma_f32_32x32x16_bf16 v[32:47], v[120:123], v[112:115], v[32:47]
  s_waitcnt vmcnt(6)
  ds_add_u32 v7, v20
  ds_read_b128 v[96:99], v12 offset:24576
  ds_read_b128 v[104:107], v18 offset:24576
  v_mfma_f32_32x32x16_bf16 v[64:79], v[120:123], v[116:119], v[64:79]
  ds_read_b128 v[100:103], v12 offset:28672
  ds_read_b128 v[108:111], v19 offset:24576
  v_mfma_f32_32x32x16_bf16 v[48:63], v[124:127], v[112:115], v[48:63]
  v_mfma_f32_32x32x16_bf16 v[80:95], v[124:127], v[116:119], v[80:95]
  s_waitcnt lgkmcnt(2)
  v_mfma_f32_32x32x16_bf16 v[32:47], v[104:107], v[96:99], v[32:47]
  ds_read_b128 v[112:115], v13 offset:24576
  ds_read_b128 v[120:123], v18 offset:25600
  s_waitcnt lgkmcnt(3)
  v_mfma_f32_32x32x16_bf16 v[64:79], v[104:107], v[100:103], v[64:79]
  ds_read_b128 v[116:119], v13 offset:28672
  ds_read_b128 v[124:127], v19 offset:25600
  s_waitcnt lgkmcnt(4)
  v_mfma_f32_32x32x16_bf16 v[48:63], v[108:111], v[96:99], v[48:63]
  ds_read_b32 v21, v6
  v_mfma_f32_32x32x16_bf16 v[80:95], v[108:111], v[100:103], v[80:95]
  s_add_u32 s62, s62, 1
  s_setprio 3
  s_waitcnt lgkmcnt(0)
  v_cmp_gt_u32 vcc, s62, v21
  s_nop 0
  s_cbranch_vccz LF_sb35d
LF_sb35:
  ds_read_b32 v21, v6
  s_waitcnt lgkmcnt(0)
  v_cmp_gt_u32 vcc, s62, v21
  s_nop 0
  s_cbranch_vccnz LF_sb35
LF_sb35d:
  s_setprio 2
  v_mfma_f32_32x32x16_bf16 v[32:47], v[120:123], v[112:115], v[32:47]
  s_waitcnt vmcnt(0)
  ds_add_u32 v7, v20
  ds_read_b128 v[96:99], v8 offset:0
  ds_read_b128 v[104:107], v14 offset:0
  v_mfma_f32_32x32x16_bf16 v[64:79], v[120:123], v[116:119], v[64:79]
  ds_read_b128 v[100:103], v8 offset:4096
  ds_read_b128 v[108:111], v15 offset:0
  v_mfma_f32_32x32x16_bf16 v[48:63], v[124:127], v[112:115], v[48:63]
  v_mfma_f32_32x32x16_bf16 v[80:95], v[124:127], v[116:119], v[80:95]
  s_mov_b32 s50, 19415040
  buffer_load_dwordx4 v[128:131], v2, s[36:39], s50 offen sc0 sc1
  s_waitcnt lgkmcnt(2)
  v_mfma_f32_32x32x16_bf16 v[32:47], v[104:107], v[96:99], v[32:47]
  ds_read_b128 v[112:115], v9 offset:0
  ds_read_b128 v[120:123], v14 offset:1024
  s_waitcnt lgkmcnt(3)
  v_mfma_f32_32x32x16_bf16 v[64:79], v[104:107], v[100:103], v[64:79]
  ds_read_b128 v[116:119], v9 offset:4096
  ds_read_b128 v[124:127], v15 offset:1024
  s_waitcnt lgkmcnt(4)
  v_mfma_f32_32x32x16_bf16 v[48:63], v[108:111], v[96:99], v[48:63]
  ds_read_b32 v21, v6
  v_mfma_f32_32x32x16_bf16 v[80:95], v[108:111], v[100:103], v[80:95]
  s_add_u32 s62, s62, 1
  s_setprio 3
  s_waitcnt lgkmcnt(0)
  v_cmp_gt_u32 vcc, s62, v21
  s_nop 0
  s_cbranch_vccz LF_sb36d
LF_sb36:
  ds_read_b32 v21, v6
  s_waitcnt lgkmcnt(0)
  v_cmp_gt_u32 vcc, s62, v21
  s_nop 0
  s_cbranch_vccnz LF_sb36
LF_sb36d:
  s_setprio 2
  v_mfma_f32_32x32x16_bf16 v[32:47], v[120:123], v[112:115], v[32:47]
  s_waitcnt vmcnt(1)
  ds_add_u32 v7, v20
  ds_read_b128 v[96:99], v8 offset:24576
  ds_read_b128 v[104:107], v14 offset:24576
  v_mfma_f32_32x32x16_bf16 v[64:79], v[120:123], v[116:119], v[64:79]
  ds_read_b128 v[100:103], v8 offset:28672
  ds_read_b128 v[108:111], v15 offset:24576
  v_mfma_f32_32x32x16_bf16 v[48:63], v[124:127], v[112:115], v[48:63]
  v_mfma_f32_32x32x16_bf16 v[80:95], v[124:127], v[116:119], v[80:95]
  s_waitcnt lgkmcnt(2)
  v_mfma_f32_32x32x16_bf16 v[32:47], v[104:107], v[96:99], v[32:47]
  ds_read_b128 v[112:115], v9 offset:24576
  ds_read_b128 v[120:123], v14 offset:25600
  s_waitcnt lgkmcnt(3)
  v_mfma_f32_32x32x16_bf16 v[64:79], v[104:107], v[100:103], v[64:79]
  ds_read_b128 v[116:119], v9 offset:28672
  ds_read_b128 v[124:127], v15 offset:25600
  s_waitcnt lgkmcnt(4)
  v_mfma_f32_32x32x16_bf16 v[48:63], v[108:111], v[96:99], v[48:63]
  ds_read_b32 v21, v6
  v_mfma_f32_32x32x16_bf16 v[80:95], v[108:111], v[100:103], v[80:95]
  s_add_u32 s62, s62, 1
  s_setprio 3
  s_waitcnt lgkmcnt(0)
  v_cmp_gt_u32 vcc, s62, v21
  s_nop 0
  s_cbranch_vccz LF_sb37d
LF_sb37:
  ds_read_b32 v21, v6
  s_waitcnt lgkmcnt(0)
  v_cmp_gt_u32 vcc, s62, v21
  s_nop 0
  s_cbranch_vccnz LF_sb37
LF_sb37d:
  s_setprio 2
  v_mfma_f32_32x32x16_bf16 v[32:47], v[120:123], v[112:115], v[32:47]
  s_waitcnt vmcnt(1)
  ds_add_u32 v7, v20
  v_mfma_f32_32x32x16_bf16 v[64:79], v[120:123], v[116:119], v[64:79]
  v_mfma_f32_32x32x16_bf16 v[48:63], v[124:127], v[112:115], v[48:63]
  v_mfma_f32_32x32x16_bf16 v[80:95], v[124:127], v[116:119], v[80:95]
  s_setprio 3
  s_lshl_b32 s48, s15, 13
  s_add_u32 s49, s48, 122880
  s_cmp_lt_u32 s43, 2
  s_cselect_b32 s50, s49, s48
  s_cselect_b32 s48, s48, s49
  v_add_u32 v22, s50, v2
  v_add_u32 v23, s48, v2
  s_nop 4
  ds_write_b128 v22, v[48:51] offset:0
  ds_write_b128 v22, v[52:55] offset:1024
  ds_write_b128 v22, v[56:59] offset:2048
  ds_write_b128 v22, v[60:63] offset:3072
  ds_write_b128 v22, v[80:83] offset:4096
  ds_write_b128 v22, v[84:87] offset:5120
  ds_write_b128 v22, v[88:91] offset:6144
  ds_write_b128 v22, v[92:95] offset:7168
  s_waitcnt lgkmcnt(0)
  ds_add_u32 v7, v20
  ds_read_b32 v21, v6
  s_add_u32 s62, s62, 2
  s_waitcnt lgkmcnt(0)
  v_cmp_gt_u32 vcc, s62, v21
  s_nop 0
  s_cbranch_vccz LF_sb38d
LF_sb38:
  ds_read_b32 v21, v6
  s_waitcnt lgkmcnt(0)
  v_cmp_gt_u32 vcc, s62, v21
  s_nop 0
  s_cbranch_vccnz LF_sb38
LF_sb38d:
  s_cmp_ge_u32 s14, 27
  s_cbranch_scc1 LF_gend
  ds_read_b128 v[48:51], v23 offset:0
  ds_read_b128 v[52:55], v23 offset:1024
  ds_read_b128 v[56:59], v23 offset:2048
  ds_read_b128 v[60:63], v23 offset:3072
  ds_read_b128 v[80:83], v23 offset:4096
  ds_read_b128 v[84:87], v23 offset:5120
  ds_read_b128 v[88:91], v23 offset:6144
  ds_read_b128 v[92:95], v23 offset:7168
  s_mul_i32 s48, s47, 96256
  s_lshl_b32 s49, s14, 11
  s_add_u32 s48, s48, s49
  s_add_u32 s48, s48, 10133504
  s_waitcnt vmcnt(0)
  s_waitcnt lgkmcnt(4)
  v_add_f32 v32, v32, v48
  v_add_f32 v33, v33, v49
  v_lshlrev_b32 v24, 16, v144
  v_and_b32 v25, v26, v144
  v_mul_f32 v24, v24, v32
  v_mul_f32 v25, v25, v33
  v_cvt_pk_bf16_f32 v144, v24, v25
  v_add_f32 v34, v34, v50
  v_add_f32 v35, v35, v51
  v_lshlrev_b32 v24, 16, v145
  v_and_b32 v25, v26, v145
  v_mul_f32 v24, v24, v34
  v_mul_f32 v25, v25, v35
  v_cvt_pk_bf16_f32 v145, v24, v25
  v_add_f32 v36, v36, v52
  v_add_f32 v37, v37, v53
  v_lshlrev_b32 v24, 16, v146
  v_and_b32 v25, v26, v146
  v_mul_f32 v24, v24, v36
  v_mul_f32 v25, v25, v37
  v_cvt_pk_bf16_f32 v146, v24, v25
  v_add_f32 v38, v38, v54
  v_add_f32 v39, v39, v55
  v_lshlrev_b32 v24, 16, v147
  v_and_b32 v25, v26, v147
  v_mul_f32 v24, v24, v38
  v_mul_f32 v25, v25, v39
  v_cvt_pk_bf16_f32 v147, v24, v25
  v_add_f32 v40, v40, v56
  v_add_f32 v41, v41, v57
  v_lshlrev_b32 v24, 16, v148
  v_and_b32 v25, v26, v148
  v_mul_f32 v24, v24, v40
  v_mul_f32 v25, v25, v41
  v_cvt_pk_bf16_f32 v148, v24, v25
  v_add_f32 v42, v42, v58
  v_add_f32 v43, v43, v59
  v_lshlrev_b32 v24, 16, v149
  v_and_b32 v25, v26, v149
  v_mul_f32 v24, v24, v42
  v_mul_f32 v25, v25, v43
  v_cvt_pk_bf16_f32 v149, v24, v25
  v_add_f32 v44, v44, v60
  v_add_f32 v45, v45, v61
  v_lshlrev_b32 v24, 16, v150
  v_and_b32 v25, v26, v150
  v_mul_f32 v24, v24, v44
  v_mul_f32 v25, v25, v45
  v_cvt_pk_bf16_f32 v150, v24, v25
  v_add_f32 v46, v46, v62
  v_add_f32 v47, v47, v63
  v_lshlrev_b32 v24, 16, v151
  v_and_b32 v25, v26, v151
  v_mul_f32 v24, v24, v46
  v_mul_f32 v25, v25, v47
  v_cvt_pk_bf16_f32 v151, v24, v25
  buffer_store_dwordx4 v[144:147], v2, s[36:39], s48 offen sc0 sc1
  buffer_store_dwordx4 v[148:151], v2, s[36:39], s48 offen offset:1024 sc0 sc1
  s_add_u32 s48, s48, 96256
  s_waitcnt lgkmcnt(0)
  v_add_f32 v64, v64, v80
  v_add_f32 v65, v65, v81
  v_lshlrev_b32 v24, 16, v152
  v_and_b32 v25, v26, v152
  v_mul_f32 v24, v24, v64
  v_mul_f32 v25, v25, v65
  v_cvt_pk_bf16_f32 v152, v24, v25
  v_add_f32 v66, v66, v82
  v_add_f32 v67, v67, v83
  v_lshlrev_b32 v24, 16, v153
  v_and_b32 v25, v26, v153
  v_mul_f32 v24, v24, v66
  v_mul_f32 v25, v25, v67
  v_cvt_pk_bf16_f32 v153, v24, v25
  v_add_f32 v68, v68, v84
  v_add_f32 v69, v69, v85
  v_lshlrev_b32 v24, 16, v154
  v_and_b32 v25, v26, v154
  v_mul_f32 v24, v24, v68
  v_mul_f32 v25, v25, v69
  v_cvt_pk_bf16_f32 v154, v24, v25
  v_add_f32 v70, v70, v86
  v_add_f32 v71, v71, v87
  v_lshlrev_b32 v24, 16, v155
  v_and_b32 v25, v26, v155
  v_mul_f32 v24, v24, v70
  v_mul_f32 v25, v25, v71
  v_cvt_pk_bf16_f32 v155, v24, v25
  v_add_f32 v72, v72, v88
  v_add_f32 v73, v73, v89
  v_lshlrev_b32 v24, 16, v156
  v_and_b32 v25, v26, v156
  v_mul_f32 v24, v24, v72
  v_mul_f32 v25, v25, v73
  v_cvt_pk_bf16_f32 v156, v24, v25
  v_add_f32 v74, v74, v90
  v_add_f32 v75, v75, v91
  v_lshlrev_b32 v24, 16, v157
  v_and_b32 v25, v26, v157
  v_mul_f32 v24, v24, v74
  v_mul_f32 v25, v25, v75
  v_cvt_pk_bf16_f32 v157, v24, v25
  v_add_f32 v76, v76, v92
  v_add_f32 v77, v77, v93
  v_lshlrev_b32 v24, 16, v158
  v_and_b32 v25, v26, v158
  v_mul_f32 v24, v24, v76
  v_mul_f32 v25, v25, v77
  v_cvt_pk_bf16_f32 v158, v24, v25
  v_add_f32 v78, v78, v94
  v_add_f32 v79, v79, v95
  v_lshlrev_b32 v24, 16, v159
  v_and_b32 v25, v26, v159
  v_mul_f32 v24, v24, v78
  v_mul_f32 v25, v25, v79
  v_cvt_pk_bf16_f32 v159, v24, v25
  buffer_store_dwordx4 v[152:155], v2, s[36:39], s48 offen sc0 sc1
  buffer_store_dwordx4 v[156:159], v2, s[36:39], s48 offen offset:1024 sc0 sc1
  s_add_u32 s48, s48, 96256
  s_lshl_b32 s49, s47, 8
  s_lshl3_add_u32 s49, s14, s49
  s_add_u32 s49, s49, 19398656
  v_lshrrev_b32 v166, 1, v1
  v_lshlrev_b32 v166, 16, v166
  v_and_b32 v167, 1, v1
  v_lshl_add_u32 v166, v167, 8, v166
  s_waitcnt vmcnt(0)
  s_mov_b32 exec_hi, 0
  s_mov_b32 exec_lo, 0x3
  buffer_store_dwordx2 v[160:161], v166, s[36:39], s49 offen sc0 sc1
  s_mov_b64 exec, -1
LF_gend:
  v_mov_b32 v20, 64
  ds_write_b32 v7, v20
  s_load_dwordx2 s[4:5], s[0:1], 0
  s_load_dwordx2 s[6:7], s[0:1], 80
  s_lshr_b32 s48, s45, 3
  s_lshl2_add_u32 s59, s44, s48
  s_and_b32 s60, s45, 7
  s_cmp_ge_u32 s42, 14
  s_cselect_b32 s58, 65536, 0
  s_cselect_b32 s51, 6, 5
LF_sp39:
  ds_read_b32 v30, v6
  s_waitcnt lgkmcnt(0)
  v_cmp_gt_u32 vcc, 64, v30
  s_nop 0
  s_cbranch_vccz LF_sp39d
  s_sleep 2
  s_branch LF_sp39
LF_sp39d:
LF_sp40:
  ds_read_b32 v30, v31
  s_waitcnt lgkmcnt(0)
  v_cmp_gt_u32 vcc, s51, v30
  s_nop 0
  s_cbranch_vccz LF_sp40d
  s_sleep 4
  s_branch LF_sp40
LF_sp40d:
  s_waitcnt vmcnt(1)
  v_cmp_ne_u64 vcc, v[128:129], v[160:161]
  v_cmp_ne_u64 s[54:55], v[130:131], v[160:161]
  s_mov_b32 s50, 19415040
  s_or_b64 vcc, vcc, s[54:55]
  s_cbranch_vccz LF_wok
  s_mov_b32 s48, 0x20000
LF_pl41:
  buffer_load_dwordx4 v[32:35], v2, s[36:39], s50 offen sc0 sc1
  s_waitcnt vmcnt(0)
  v_cmp_ne_u64 vcc, v[32:33], v[160:161]
  s_nop 0
  v_cmp_ne_u64 s[54:55], v[34:35], v[160:161]
  s_nop 0
  s_or_b64 vcc, vcc, s[54:55]
  s_cbranch_vccz LF_pl41d
  s_sleep 16
  s_sub_u32 s48, s48, 1
  s_cbranch_scc0 LF_pl41
LF_pl41d:
LF_wok:
  s_add_u32 s48, s43, 20
  s_mul_i32 s56, s59, 192512
  s_lshl_b32 s49, s48, 11
  s_add_u32 s56, s56, s49
  s_add_u32 s56, s56, 10092544
  s_mul_i32 s57, s60, 47
  s_add_u32 s57, s57, s48
  s_mul_i32 s57, s57, 5120
  s_add_u32 s57, s57, 16252928
  s_mul_i32 s61, s43, 15360
  s_cmp_eq_u32 s43, 3
  s_cselect_b32 s61, 122880, s61
  s_mul_i32 s63, s43, 12288
  s_add_u32 s63, s63, 49152
  s_sleep 1
  s_add_u32 s51, s57, 4096
  buffer_load_dwordx4 v[104:107], v2, s[36:39], s57 offen offset:0 sc1
  buffer_load_dwordx4 v[108:111], v2, s[36:39], s57 offen offset:1024 sc1
  buffer_load_dwordx4 v[112:115], v2, s[36:39], s57 offen offset:2048 sc1
  buffer_load_dwordx4 v[116:119], v2, s[36:39], s57 offen offset:3072 sc1
  buffer_load_dwordx4 v[120:123], v2, s[36:39], s51 offen sc1
  s_add_u32 s57, s57, 20480
  s_waitcnt vmcnt(5)
  s_add_u32 s51, s57, 4096
  buffer_load_dwordx4 v[140:143], v2, s[36:39], s57 offen offset:0 sc1
  buffer_load_dwordx4 v[144:147], v2, s[36:39], s57 offen offset:1024 sc1
  buffer_load_dwordx4 v[148:151], v2, s[36:39], s57 offen offset:2048 sc1
  buffer_load_dwordx4 v[152:155], v2, s[36:39], s57 offen offset:3072 sc1
  buffer_load_dwordx4 v[156:159], v2, s[36:39], s51 offen sc1
  s_add_u32 s57, s57, 20480
  s_waitcnt vmcnt(5)
  s_add_u32 m0, s61, 0
  s_add_u32 s51, s57, 4096
  buffer_load_dwordx4 v2, s[36:39], s57 offen offset:0 sc1 lds
  buffer_load_dwordx4 v2, s[36:39], s57 offen offset:1024 sc1 lds
  buffer_load_dwordx4 v2, s[36:39], s57 offen offset:2048 sc1 lds
  buffer_load_dwordx4 v2, s[36:39], s57 offen offset:3072 sc1 lds
  s_add_u32 m0, s61, 4096
  s_add_u32 s57, s57, 20480
  buffer_load_dwordx4 v2, s[36:39], s51 offen sc1 lds
  s_waitcnt vmcnt(5)
  s_add_u32 m0, s61, 5120
  s_add_u32 s51, s57, 4096
  buffer_load_dwordx4 v2, s[36:39], s57 offen offset:0 sc1 lds
  buffer_load_dwordx4 v2, s[36:39], s57 offen offset:1024 sc1 lds
  buffer_load_dwordx4 v2, s[36:39], s57 offen offset:2048 sc1 lds
  buffer_load_dwordx4 v2, s[36:39], s57 offen offset:3072 sc1 lds
  s_add_u32 m0, s61, 9216
  s_add_u32 s57, s57, 20480
  buffer_load_dwordx4 v2, s[36:39], s51 offen sc1 lds
  s_waitcnt vmcnt(5)
  s_add_u32 m0, s61, 10240
  s_add_u32 s51, s57, 4096
  buffer_load_dwordx4 v2, s[36:39], s57 offen offset:0 sc1 lds
  buffer_load_dwordx4 v2, s[36:39], s57 offen offset:1024 sc1 lds
  buffer_load_dwordx4 v2, s[36:39], s57 offen offset:2048 sc1 lds
  buffer_load_dwordx4 v2, s[36:39], s57 offen offset:3072 sc1 lds
  s_add_u32 m0, s61, 14336
  s_add_u32 s57, s57, 20480
  buffer_load_dwordx4 v2, s[36:39], s51 offen sc1 lds
  v_lshrrev_b32 v124, 4, v1
  v_and_b32 v125, 0xf0, v2
  v_lshl_add_u32 v4, v124, 9, v125
  v_subrev_u32 v5, 512, v0
  v_add_u32 v166, s61, v2
  v_mov_b32 v8, 0
  v_mov_b32 v9, 0
  v_mov_b32 v10, 0
  v_mov_b32 v11, 0
  v_mov_b32 v12, 0
  v_mov_b32 v13, 0
  v_mov_b32 v14, 0
  v_mov_b32 v15, 0
  v_mov_b32 v16, 0
  v_mov_b32 v17, 0
  v_mov_b32 v18, 0
  v_mov_b32 v19, 0
  v_mov_b32 v20, 0
  v_mov_b32 v21, 0
  v_mov_b32 v22, 0
  v_mov_b32 v23, 0
  v_mov_b32 v24, 0
  v_mov_b32 v25, 0
  v_mov_b32 v26, 0
  v_mov_b32 v27, 0
  v_mov_b32 v28, 0
  v_mov_b32 v29, 0
  v_mov_b32 v30, 0
  v_mov_b32 v31, 0
  v_mov_b32 v32, 0
  v_mov_b32 v33, 0
  v_mov_b32 v34, 0
  v_mov_b32 v35, 0
  v_mov_b32 v36, 0
  v_mov_b32 v37, 0
  v_mov_b32 v38, 0
  v_mov_b32 v39, 0
  v_mov_b32 v40, 0
  v_mov_b32 v41, 0
  v_mov_b32 v42, 0
  v_mov_b32 v43, 0
  v_mov_b32 v44, 0
  v_mov_b32 v45, 0
  v_mov_b32 v46, 0
  v_mov_b32 v47, 0
  v_mov_b32 v48, 0
  v_mov_b32 v49, 0
  v_mov_b32 v50, 0
  v_mov_b32 v51, 0
  v_mov_b32 v52, 0
  v_mov_b32 v53, 0
  v_mov_b32 v54, 0
  v_mov_b32 v55, 0
  v_mov_b32 v56, 0
  v_mov_b32 v57, 0
  v_mov_b32 v58, 0
  v_mov_b32 v59, 0
  v_mov_b32 v60, 0
  v_mov_b32 v61, 0
  v_mov_b32 v62, 0
  v_mov_b32 v63, 0
  v_mov_b32 v64, 0
  v_mov_b32 v65, 0
  v_mov_b32 v66, 0
  v_mov_b32 v67, 0
  v_mov_b32 v68, 0
  v_mov_b32 v69, 0
  v_mov_b32 v70, 0
  v_mov_b32 v71, 0
  v_mov_b32 v72, 0
  v_mov_b32 v73, 0
  v_mov_b32 v74, 0
  v_mov_b32 v75, 0
  v_mov_b32 v76, 0
  v_mov_b32 v77, 0
  v_mov_b32 v78, 0
  v_mov_b32 v79, 0
  v_mov_b32 v80, 0
  v_mov_b32 v81, 0
  v_mov_b32 v82, 0
  v_mov_b32 v83, 0
  v_mov_b32 v84, 0
  v_mov_b32 v85, 0
  v_mov_b32 v86, 0
  v_mov_b32 v87, 0
  s_cmp_lg_u32 s43, 0
  s_cbranch_scc1 LF_h0
  s_lshl_b32 s49, s59, 9
  s_add_u32 s49, s49, 19398656
  s_cmp_eq_u32 s58, 0
  s_cbranch_scc1 LF_hh
  s_sleep 50
LF_hh:
  v_and_b32 v88, 0xf8, v3
  v_min_u32 v88, 208, v88
  v_and_b32 v89, 0x100, v3
  v_or_b32 v88, v88, v89
  s_sleep 1
  s_mov_b32 s48, 0x20000
LF_pl42:
  buffer_load_dwordx2 v[90:91], v88, s[36:39], s49 offen sc0 sc1
  s_waitcnt vmcnt(0)
  v_cmp_ne_u64 vcc, v[90:91], v[160:161]
  s_nop 0
  s_cbranch_vccz LF_pl42d
  s_sleep 8
  s_sub_u32 s48, s48, 1
  s_cbranch_scc0 LF_pl42
LF_pl42d:
  v_mov_b32 v164, 65
  ds_write_b32 v7, v164
LF_h0:
  s_lshl2_add_u32 s48, s60, s43
  s_lshr_b32 s49, s48, 4
  s_lshl1_add_u32 s49, s59, s49
  s_mul_i32 s50, s49, 96256
  s_and_b32 s48, s48, 15
  s_lshl_b32 s48, s48, 7
  s_add_u32 s50, s50, s48
  s_add_u32 s50, s50, 10133504
  v_lshlrev_b32 v167, 11, v1
  v_mov_b32 v165, 160768
LF_sp43:
  ds_read_b32 v164, v165
  s_waitcnt lgkmcnt(0)
  v_cmp_gt_u32 vcc, 65, v164
  s_nop 0
  s_cbranch_vccz LF_sp43d
  s_sleep 2
  s_branch LF_sp43
LF_sp43d:
  s_setprio 1
  s_mov_b64 exec, 0x7ffffff
  buffer_load_dword v167, v167, s[36:39], s50 offen sc1
  s_mov_b64 exec, -1
  s_add_u32 s49, s56, 96256
  buffer_load_dwordx4 v[88:91], v4, s[36:39], s56 offen sc1
  buffer_load_dwordx4 v[92:95], v4, s[36:39], s56 offen offset:256 sc1
  buffer_load_dwordx4 v[96:99], v4, s[36:39], s49 offen sc1
  buffer_load_dwordx4 v[100:103], v4, s[36:39], s49 offen offset:256 sc1
  s_add_u32 s56, s56, 8192
  s_add_u32 s49, s56, 96256
  buffer_load_dwordx4 v[124:127], v4, s[36:39], s56 offen sc1
  buffer_load_dwordx4 v[128:131], v4, s[36:39], s56 offen offset:256 sc1
  buffer_load_dwordx4 v[132:135], v4, s[36:39], s49 offen sc1
  buffer_load_dwordx4 v[136:139], v4, s[36:39], s49 offen offset:256 sc1
  s_add_u32 s56, s56, 8192
  s_waitcnt vmcnt(4)
  v_mfma_f32_16x16x32_bf16 v[8:11], v[104:107], v[88:91], v[8:11]
  v_mfma_f32_16x16x32_bf16 v[12:15], v[104:107], v[92:95], v[12:15]
  v_mfma_f32_16x16x32_bf16 v[16:19], v[104:107], v[96:99], v[16:19]
  v_mfma_f32_16x16x32_bf16 v[20:23], v[104:107], v[100:103], v[20:23]
  v_mfma_f32_16x16x32_bf16 v[24:27], v[108:111], v[88:91], v[24:27]
  v_mfma_f32_16x16x32_bf16 v[28:31], v[108:111], v[92:95], v[28:31]
  v_mfma_f32_16x16x32_bf16 v[32:35], v[108:111], v[96:99], v[32:35]
  v_mfma_f32_16x16x32_bf16 v[36:39], v[108:111], v[100:103], v[36:39]
  v_mfma_f32_16x16x32_bf16 v[40:43], v[112:115], v[88:91], v[40:43]
  v_mfma_f32_16x16x32_bf16 v[44:47], v[112:115], v[92:95], v[44:47]
  v_mfma_f32_16x16x32_bf16 v[48:51], v[112:115], v[96:99], v[48:51]
  v_mfma_f32_16x16x32_bf16 v[52:55], v[112:115], v[100:103], v[52:55]
  v_mfma_f32_16x16x32_bf16 v[56:59], v[116:119], v[88:91], v[56:59]
  v_mfma_f32_16x16x32_bf16 v[60:63], v[116:119], v[92:95], v[60:63]
  v_mfma_f32_16x16x32_bf16 v[64:67], v[116:119], v[96:99], v[64:67]
  v_mfma_f32_16x16x32_bf16 v[68:71], v[116:119], v[100:103], v[68:71]
  v_mfma_f32_16x16x32_bf16 v[72:75], v[120:123], v[88:91], v[72:75]
  v_mfma_f32_16x16x32_bf16 v[76:79], v[120:123], v[92:95], v[76:79]
  v_mfma_f32_16x16x32_bf16 v[80:83], v[120:123], v[96:99], v[80:83]
  v_mfma_f32_16x16x32_bf16 v[84:87], v[120:123], v[100:103], v[84:87]
  s_add_u32 s49, s56, 96256
  buffer_load_dwordx4 v[88:91], v4, s[36:39], s56 offen sc1
  buffer_load_dwordx4 v[92:95], v4, s[36:39], s56 offen offset:256 sc1
  buffer_load_dwordx4 v[96:99], v4, s[36:39], s49 offen sc1
  buffer_load_dwordx4 v[100:103], v4, s[36:39], s49 offen offset:256 sc1
  s_add_u32 s56, s56, 8192
  ds_read_b128 v[104:107], v166 offset:0
  ds_read_b128 v[108:111], v166 offset:1024
  ds_read_b128 v[112:115], v166 offset:2048
  ds_read_b128 v[116:119], v166 offset:3072
  ds_read_b128 v[120:123], v166 offset:4096
  s_waitcnt vmcnt(4)
  v_mfma_f32_16x16x32_bf16 v[8:11], v[140:143], v[124:127], v[8:11]
  v_mfma_f32_16x16x32_bf16 v[12:15], v[140:143], v[128:131], v[12:15]
  v_mfma_f32_16x16x32_bf16 v[16:19], v[140:143], v[132:135], v[16:19]
  v_mfma_f32_16x16x32_bf16 v[20:23], v[140:143], v[136:139], v[20:23]
  v_mfma_f32_16x16x32_bf16 v[24:27], v[144:147], v[124:127], v[24:27]
  v_mfma_f32_16x16x32_bf16 v[28:31], v[144:147], v[128:131], v[28:31]
  v_mfma_f32_16x16x32_bf16 v[32:35], v[144:147], v[132:135], v[32:35]
  v_mfma_f32_16x16x32_bf16 v[36:39], v[144:147], v[136:139], v[36:39]
  v_mfma_f32_16x16x32_bf16 v[40:43], v[148:151], v[124:127], v[40:43]
  v_mfma_f32_16x16x32_bf16 v[44:47], v[148:151], v[128:131], v[44:47]
  v_mfma_f32_16x16x32_bf16 v[48:51], v[148:151], v[132:135], v[48:51]
  v_mfma_f32_16x16x32_bf16 v[52:55], v[148:151], v[136:139], v[52:55]
  v_mfma_f32_16x16x32_bf16 v[56:59], v[152:155], v[124:127], v[56:59]
  v_mfma_f32_16x16x32_bf16 v[60:63], v[152:155], v[128:131], v[60:63]
  v_mfma_f32_16x16x32_bf16 v[64:67], v[152:155], v[132:135], v[64:67]
  v_mfma_f32_16x16x32_bf16 v[68:71], v[152:155], v[136:139], v[68:71]
  v_mfma_f32_16x16x32_bf16 v[72:75], v[156:159], v[124:127], v[72:75]
  v_mfma_f32_16x16x32_bf16 v[76:79], v[156:159], v[128:131], v[76:79]
  v_mfma_f32_16x16x32_bf16 v[80:83], v[156:159], v[132:135], v[80:83]
  v_mfma_f32_16x16x32_bf16 v[84:87], v[156:159], v[136:139], v[84:87]
  s_add_u32 s49, s56, 96256
  buffer_load_dwordx4 v[124:127], v4, s[36:39], s56 offen sc1
  buffer_load_dwordx4 v[128:131], v4, s[36:39], s56 offen offset:256 sc1
  buffer_load_dwordx4 v[132:135], v4, s[36:39], s49 offen sc1
  buffer_load_dwordx4 v[136:139], v4, s[36:39], s49 offen offset:256 sc1
  s_add_u32 s56, s56, 8192
  ds_read_b128 v[140:143], v166 offset:5120
  ds_read_b128 v[144:147], v166 offset:6144
  ds_read_b128 v[148:151], v166 offset:7168
  ds_read_b128 v[152:155], v166 offset:8192
  ds_read_b128 v[156:159], v166 offset:9216
  s_waitcnt vmcnt(4) lgkmcnt(5)
  v_mfma_f32_16x16x32_bf16 v[8:11], v[104:107], v[88:91], v[8:11]
  v_mfma_f32_16x16x32_bf16 v[12:15], v[104:107], v[92:95], v[12:15]
  v_mfma_f32_16x16x32_bf16 v[16:19], v[104:107], v[96:99], v[16:19]
  v_mfma_f32_16x16x32_bf16 v[20:23], v[104:107], v[100:103], v[20:23]
  v_mfma_f32_16x16x32_bf16 v[24:27], v[108:111], v[88:91], v[24:27]
  v_mfma_f32_16x16x32_bf16 v[28:31], v[108:111], v[92:95], v[28:31]
  v_mfma_f32_16x16x32_bf16 v[32:35], v[108:111], v[96:99], v[32:35]
  v_mfma_f32_16x16x32_bf16 v[36:39], v[108:111], v[100:103], v[36:39]
  v_mfma_f32_16x16x32_bf16 v[40:43], v[112:115], v[88:91], v[40:43]
  v_mfma_f32_16x16x32_bf16 v[44:47], v[112:115], v[92:95], v[44:47]
  v_mfma_f32_16x16x32_bf16 v[48:51], v[112:115], v[96:99], v[48:51]
  v_mfma_f32_16x16x32_bf16 v[52:55], v[112:115], v[100:103], v[52:55]
  v_mfma_f32_16x16x32_bf16 v[56:59], v[116:119], v[88:91], v[56:59]
  v_mfma_f32_16x16x32_bf16 v[60:63], v[116:119], v[92:95], v[60:63]
  v_mfma_f32_16x16x32_bf16 v[64:67], v[116:119], v[96:99], v[64:67]
  v_mfma_f32_16x16x32_bf16 v[68:71], v[116:119], v[100:103], v[68:71]
  v_mfma_f32_16x16x32_bf16 v[72:75], v[120:123], v[88:91], v[72:75]
  v_mfma_f32_16x16x32_bf16 v[76:79], v[120:123], v[92:95], v[76:79]
  v_mfma_f32_16x16x32_bf16 v[80:83], v[120:123], v[96:99], v[80:83]
  v_mfma_f32_16x16x32_bf16 v[84:87], v[120:123], v[100:103], v[84:87]
  s_add_u32 s49, s56, 96256
  buffer_load_dwordx4 v[88:91], v4, s[36:39], s56 offen sc1
  buffer_load_dwordx4 v[92:95], v4, s[36:39], s56 offen offset:256 sc1
  buffer_load_dwordx4 v[96:99], v4, s[36:39], s49 offen sc1
  buffer_load_dwordx4 v[100:103], v4, s[36:39], s49 offen offset:256 sc1
  s_add_u32 s56, s56, 8192
  ds_read_b128 v[104:107], v166 offset:10240
  ds_read_b128 v[108:111], v166 offset:11264
  ds_read_b128 v[112:115], v166 offset:12288
  ds_read_b128 v[116:119], v166 offset:13312
  ds_read_b128 v[120:123], v166 offset:14336
  s_waitcnt vmcnt(4) lgkmcnt(5)
  v_mfma_f32_16x16x32_bf16 v[8:11], v[140:143], v[124:127], v[8:11]
  v_mfma_f32_16x16x32_bf16 v[12:15], v[140:143], v[128:131], v[12:15]
  v_mfma_f32_16x16x32_bf16 v[16:19], v[140:143], v[132:135], v[16:19]
  v_mfma_f32_16x16x32_bf16 v[20:23], v[140:143], v[136:139], v[20:23]
  v_mfma_f32_16x16x32_bf16 v[24:27], v[144:147], v[124:127], v[24:27]
  v_mfma_f32_16x16x32_bf16 v[28:31], v[144:147], v[128:131], v[28:31]
  v_mfma_f32_16x16x32_bf16 v[32:35], v[144:147], v[132:135], v[32:35]
  v_mfma_f32_16x16x32_bf16 v[36:39], v[144:147], v[136:139], v[36:39]
  v_mfma_f32_16x16x32_bf16 v[40:43], v[148:151], v[124:127], v[40:43]
  v_mfma_f32_16x16x32_bf16 v[44:47], v[148:151], v[128:131], v[44:47]
  v_mfma_f32_16x16x32_bf16 v[48:51], v[148:151], v[132:135], v[48:51]
  v_mfma_f32_16x16x32_bf16 v[52:55], v[148:151], v[136:139], v[52:55]
  v_mfma_f32_16x16x32_bf16 v[56:59], v[152:155], v[124:127], v[56:59]
  v_mfma_f32_16x16x32_bf16 v[60:63], v[152:155], v[128:131], v[60:63]
  v_mfma_f32_16x16x32_bf16 v[64:67], v[152:155], v[132:135], v[64:67]
  v_mfma_f32_16x16x32_bf16 v[68:71], v[152:155], v[136:139], v[68:71]
  v_mfma_f32_16x16x32_bf16 v[72:75], v[156:159], v[124:127], v[72:75]
  v_mfma_f32_16x16x32_bf16 v[76:79], v[156:159], v[128:131], v[76:79]
  v_mfma_f32_16x16x32_bf16 v[80:83], v[156:159], v[132:135], v[80:83]
  v_mfma_f32_16x16x32_bf16 v[84:87], v[156:159], v[136:139], v[84:87]
  s_add_u32 s49, s56, 96256
  buffer_load_dwordx4 v[124:127], v4, s[36:39], s56 offen sc1
  buffer_load_dwordx4 v[128:131], v4, s[36:39], s56 offen offset:256 sc1
  buffer_load_dwordx4 v[132:135], v4, s[36:39], s49 offen sc1
  buffer_load_dwordx4 v[136:139], v4, s[36:39], s49 offen offset:256 sc1
  s_add_u32 s56, s56, 8192
  s_add_u32 s51, s57, 4096
  buffer_load_dwordx4 v[140:143], v2, s[36:39], s57 offen offset:0 sc1
  buffer_load_dwordx4 v[144:147], v2, s[36:39], s57 offen offset:1024 sc1
  buffer_load_dwordx4 v[148:151], v2, s[36:39], s57 offen offset:2048 sc1
  buffer_load_dwordx4 v[152:155], v2, s[36:39], s57 offen offset:3072 sc1
  buffer_load_dwordx4 v[156:159], v2, s[36:39], s51 offen sc1
  s_add_u32 s57, s57, 20480
  s_waitcnt vmcnt(9) lgkmcnt(0)
  v_mfma_f32_16x16x32_bf16 v[8:11], v[104:107], v[88:91], v[8:11]
  v_mfma_f32_16x16x32_bf16 v[12:15], v[104:107], v[92:95], v[12:15]
  v_mfma_f32_16x16x32_bf16 v[16:19], v[104:107], v[96:99], v[16:19]
  v_mfma_f32_16x16x32_bf16 v[20:23], v[104:107], v[100:103], v[20:23]
  v_mfma_f32_16x16x32_bf16 v[24:27], v[108:111], v[88:91], v[24:27]
  v_mfma_f32_16x16x32_bf16 v[28:31], v[108:111], v[92:95], v[28:31]
  v_mfma_f32_16x16x32_bf16 v[32:35], v[108:111], v[96:99], v[32:35]
  v_mfma_f32_16x16x32_bf16 v[36:39], v[108:111], v[100:103], v[36:39]
  v_mfma_f32_16x16x32_bf16 v[40:43], v[112:115], v[88:91], v[40:43]
  v_mfma_f32_16x16x32_bf16 v[44:47], v[112:115], v[92:95], v[44:47]
  v_mfma_f32_16x16x32_bf16 v[48:51], v[112:115], v[96:99], v[48:51]
  v_mfma_f32_16x16x32_bf16 v[52:55], v[112:115], v[100:103], v[52:55]
  v_mfma_f32_16x16x32_bf16 v[56:59], v[116:119], v[88:91], v[56:59]
  v_mfma_f32_16x16x32_bf16 v[60:63], v[116:119], v[92:95], v[60:63]
  v_mfma_f32_16x16x32_bf16 v[64:67], v[116:119], v[96:99], v[64:67]
  v_mfma_f32_16x16x32_bf16 v[68:71], v[116:119], v[100:103], v[68:71]
  v_mfma_f32_16x16x32_bf16 v[72:75], v[120:123], v[88:91], v[72:75]
  v_mfma_f32_16x16x32_bf16 v[76:79], v[120:123], v[92:95], v[76:79]
  v_mfma_f32_16x16x32_bf16 v[80:83], v[120:123], v[96:99], v[80:83]
  v_mfma_f32_16x16x32_bf16 v[84:87], v[120:123], v[100:103], v[84:87]
  s_cmp_eq_u32 s43, 3
  s_cselect_b32 s38, 0, s38
  s_add_u32 s49, s56, 96256
  buffer_load_dwordx4 v[88:91], v4, s[36:39], s56 offen sc1
  buffer_load_dwordx4 v[92:95], v4, s[36:39], s56 offen offset:256 sc1
  buffer_load_dwordx4 v[96:99], v4, s[36:39], s49 offen sc1
  buffer_load_dwordx4 v[100:103], v4, s[36:39], s49 offen offset:256 sc1
  s_add_u32 s56, s56, 8192
  s_add_u32 s51, s57, 4096
  buffer_load_dwordx4 v[104:107], v2, s[36:39], s57 offen offset:0 sc1
  buffer_load_dwordx4 v[108:111], v2, s[36:39], s57 offen offset:1024 sc1
  buffer_load_dwordx4 v[112:115], v2, s[36:39], s57 offen offset:2048 sc1
  buffer_load_dwordx4 v[116:119], v2, s[36:39], s57 offen offset:3072 sc1
  buffer_load_dwordx4 v[120:123], v2, s[36:39], s51 offen sc1
  s_add_u32 s57, s57, 20480
  s_mov_b32 s38, 23592960
  s_add_u32 s48, s43, 0
  s_mul_i32 s56, s59, 192512
  s_lshl_b32 s49, s48, 11
  s_add_u32 s56, s56, s49
  s_add_u32 s56, s56, 10092544
  s_mul_i32 s57, s60, 47
  s_add_u32 s57, s57, s48
  s_mul_i32 s57, s57, 5120
  s_add_u32 s57, s57, 16252928
  s_waitcnt vmcnt(9)
  v_mfma_f32_16x16x32_bf16 v[8:11], v[140:143], v[124:127], v[8:11]
  v_mfma_f32_16x16x32_bf16 v[12:15], v[140:143], v[128:131], v[12:15]
  v_mfma_f32_16x16x32_bf16 v[16:19], v[140:143], v[132:135], v[16:19]
  v_mfma_f32_16x16x32_bf16 v[20:23], v[140:143], v[136:139], v[20:23]
  v_mfma_f32_16x16x32_bf16 v[24:27], v[144:147], v[124:127], v[24:27]
  v_mfma_f32_16x16x32_bf16 v[28:31], v[144:147], v[128:131], v[28:31]
  v_mfma_f32_16x16x32_bf16 v[32:35], v[144:147], v[132:135], v[32:35]
  v_mfma_f32_16x16x32_bf16 v[36:39], v[144:147], v[136:139], v[36:39]
  v_mfma_f32_16x16x32_bf16 v[40:43], v[148:151], v[124:127], v[40:43]
  v_mfma_f32_16x16x32_bf16 v[44:47], v[148:151], v[128:131], v[44:47]
  v_mfma_f32_16x16x32_bf16 v[48:51], v[148:151], v[132:135], v[48:51]
  v_mfma_f32_16x16x32_bf16 v[52:55], v[148:151], v[136:139], v[52:55]
  v_mfma_f32_16x16x32_bf16 v[56:59], v[152:155], v[124:127], v[56:59]
  v_mfma_f32_16x16x32_bf16 v[60:63], v[152:155], v[128:131], v[60:63]
  v_mfma_f32_16x16x32_bf16 v[64:67], v[152:155], v[132:135], v[64:67]
  v_mfma_f32_16x16x32_bf16 v[68:71], v[152:155], v[136:139], v[68:71]
  v_mfma_f32_16x16x32_bf16 v[72:75], v[156:159], v[124:127], v[72:75]
  v_mfma_f32_16x16x32_bf16 v[76:79], v[156:159], v[128:131], v[76:79]
  v_mfma_f32_16x16x32_bf16 v[80:83], v[156:159], v[132:135], v[80:83]
  v_mfma_f32_16x16x32_bf16 v[84:87], v[156:159], v[136:139], v[84:87]
  s_add_u32 s51, s57, 4096
  buffer_load_dwordx4 v[140:143], v2, s[36:39], s57 offen offset:0 sc1
  buffer_load_dwordx4 v[144:147], v2, s[36:39], s57 offen offset:1024 sc1
  buffer_load_dwordx4 v[148:151], v2, s[36:39], s57 offen offset:2048 sc1
  buffer_load_dwordx4 v[152:155], v2, s[36:39], s57 offen offset:3072 sc1
  buffer_load_dwordx4 v[156:159], v2, s[36:39], s51 offen sc1
  s_add_u32 s57, s57, 20480
  s_waitcnt vmcnt(5)
  v_mfma_f32_16x16x32_bf16 v[8:11], v[104:107], v[88:91], v[8:11]
  v_mfma_f32_16x16x32_bf16 v[12:15], v[104:107], v[92:95], v[12:15]
  v_mfma_f32_16x16x32_bf16 v[16:19], v[104:107], v[96:99], v[16:19]
  v_mfma_f32_16x16x32_bf16 v[20:23], v[104:107], v[100:103], v[20:23]
  v_mfma_f32_16x16x32_bf16 v[24:27], v[108:111], v[88:91], v[24:27]
  v_mfma_f32_16x16x32_bf16 v[28:31], v[108:111], v[92:95], v[28:31]
  v_mfma_f32_16x16x32_bf16 v[32:35], v[108:111], v[96:99], v[32:35]
  v_mfma_f32_16x16x32_bf16 v[36:39], v[108:111], v[100:103], v[36:39]
  v_mfma_f32_16x16x32_bf16 v[40:43], v[112:115], v[88:91], v[40:43]
  v_mfma_f32_16x16x32_bf16 v[44:47], v[112:115], v[92:95], v[44:47]
  v_mfma_f32_16x16x32_bf16 v[48:51], v[112:115], v[96:99], v[48:51]
  v_mfma_f32_16x16x32_bf16 v[52:55], v[112:115], v[100:103], v[52:55]
  v_mfma_f32_16x16x32_bf16 v[56:59], v[116:119], v[88:91], v[56:59]
  v_mfma_f32_16x16x32_bf16 v[60:63], v[116:119], v[92:95], v[60:63]
  v_mfma_f32_16x16x32_bf16 v[64:67], v[116:119], v[96:99], v[64:67]
  v_mfma_f32_16x16x32_bf16 v[68:71], v[116:119], v[100:103], v[68:71]
  v_mfma_f32_16x16x32_bf16 v[72:75], v[120:123], v[88:91], v[72:75]
  v_mfma_f32_16x16x32_bf16 v[76:79], v[120:123], v[92:95], v[76:79]
  v_mfma_f32_16x16x32_bf16 v[80:83], v[120:123], v[96:99], v[80:83]
  v_mfma_f32_16x16x32_bf16 v[84:87], v[120:123], v[100:103], v[84:87]
  s_add_u32 s51, s57, 4096
  buffer_load_dwordx4 v[104:107], v2, s[36:39], s57 offen offset:0 sc1
  buffer_load_dwordx4 v[108:111], v2, s[36:39], s57 offen offset:1024 sc1
  buffer_load_dwordx4 v[112:115], v2, s[36:39], s57 offen offset:2048 sc1
  buffer_load_dwordx4 v[116:119], v2, s[36:39], s57 offen offset:3072 sc1
  buffer_load_dwordx4 v[120:123], v2, s[36:39], s51 offen sc1
  s_add_u32 s57, s57, 20480
  s_waitcnt vmcnt(5)
  s_add_u32 m0, s61, 0
  s_add_u32 s51, s57, 4096
  buffer_load_dwordx4 v2, s[36:39], s57 offen offset:0 sc1 lds
  buffer_load_dwordx4 v2, s[36:39], s57 offen offset:1024 sc1 lds
  buffer_load_dwordx4 v2, s[36:39], s57 offen offset:2048 sc1 lds
  buffer_load_dwordx4 v2, s[36:39], s57 offen offset:3072 sc1 lds
  s_add_u32 m0, s61, 4096
  s_add_u32 s57, s57, 20480
  buffer_load_dwordx4 v2, s[36:39], s51 offen sc1 lds
  s_waitcnt vmcnt(5)
  s_add_u32 m0, s61, 5120
  s_add_u32 s51, s57, 4096
  buffer_load_dwordx4 v2, s[36:39], s57 offen offset:0 sc1 lds
  buffer_load_dwordx4 v2, s[36:39], s57 offen offset:1024 sc1 lds
  buffer_load_dwordx4 v2, s[36:39], s57 offen offset:2048 sc1 lds
  buffer_load_dwordx4 v2, s[36:39], s57 offen offset:3072 sc1 lds
  s_add_u32 m0, s61, 9216
  s_add_u32 s57, s57, 20480
  buffer_load_dwordx4 v2, s[36:39], s51 offen sc1 lds
  s_waitcnt vmcnt(5)
  s_add_u32 m0, s61, 10240
  s_add_u32 s51, s57, 4096
  buffer_load_dwordx4 v2, s[36:39], s57 offen offset:0 sc1 lds
  buffer_load_dwordx4 v2, s[36:39], s57 offen offset:1024 sc1 lds
  buffer_load_dwordx4 v2, s[36:39], s57 offen offset:2048 sc1 lds
  buffer_load_dwordx4 v2, s[36:39], s57 offen offset:3072 sc1 lds
  s_add_u32 m0, s61, 14336
  s_add_u32 s57, s57, 20480
  buffer_load_dwordx4 v2, s[36:39], s51 offen sc1 lds
  s_mov_b32 s24, s4
  s_mov_b32 s25, s5
  s_mov_b32 s26, 2621440
  s_mov_b32 s27, 0x20000
  s_mov_b32 s28, s6
  s_mov_b32 s29, s7
  s_mov_b32 s30, 2621440
  s_mov_b32 s31, 0x20000
  s_mul_i32 s58, s59, 81920
  s_mul_i32 s48, s60, 160
  s_add_u32 s58, s58, s48
  v_add_u32 v166, s61, v2
  v_add_u32 v167, s63, v2
  s_sub_u32 s50, s50, 40960
  v_lshlrev_b32 v162, 11, v1
  v_mov_b32 v165, 160352
LF_sp44:
  ds_read_b32 v164, v165
  s_waitcnt lgkmcnt(0)
  v_cmp_gt_u32 vcc, 1, v164
  s_nop 0
  s_cbranch_vccz LF_sp44d
  s_sleep 1
  s_branch LF_sp44
LF_sp44d:
  s_setprio 3
  s_add_u32 s49, s56, 96256
  buffer_load_dwordx4 v[124:127], v4, s[36:39], s56 offen sc1
  buffer_load_dwordx4 v[128:131], v4, s[36:39], s56 offen offset:256 sc1
  buffer_load_dwordx4 v[132:135], v4, s[36:39], s49 offen sc1
  buffer_load_dwordx4 v[136:139], v4, s[36:39], s49 offen offset:256 sc1
  s_add_u32 s56, s56, 8192
  s_add_u32 s49, s56, 96256
  buffer_load_dwordx4 v[88:91], v4, s[36:39], s56 offen sc1
  buffer_load_dwordx4 v[92:95], v4, s[36:39], s56 offen offset:256 sc1
  buffer_load_dwordx4 v[96:99], v4, s[36:39], s49 offen sc1
  buffer_load_dwordx4 v[100:103], v4, s[36:39], s49 offen offset:256 sc1
  s_add_u32 s56, s56, 8192
  s_add_u32 s49, s56, 96256
  s_add_u32 m0, s63, 0
  s_nop 0
  buffer_load_dwordx4 v4, s[36:39], s56 offen offset:0 sc1 lds
  s_add_u32 m0, s63, 768
  s_nop 0
  buffer_load_dwordx4 v4, s[36:39], s56 offen offset:256 sc1 lds
  s_add_u32 m0, s63, 2048
  s_nop 0
  buffer_load_dwordx4 v4, s[36:39], s49 offen offset:0 sc1 lds
  s_add_u32 m0, s63, 2816
  s_nop 0
  buffer_load_dwordx4 v4, s[36:39], s49 offen offset:256 sc1 lds
  s_add_u32 s56, s56, 8192
  s_add_u32 s49, s56, 96256
  s_add_u32 m0, s63, 4096
  s_nop 0
  buffer_load_dwordx4 v4, s[36:39], s56 offen offset:0 sc1 lds
  s_add_u32 m0, s63, 4864
  s_nop 0
  buffer_load_dwordx4 v4, s[36:39], s56 offen offset:256 sc1 lds
  s_add_u32 m0, s63, 6144
  s_nop 0
  buffer_load_dwordx4 v4, s[36:39], s49 offen offset:0 sc1 lds
  s_add_u32 m0, s63, 6912
  s_nop 0
  buffer_load_dwordx4 v4, s[36:39], s49 offen offset:256 sc1 lds
  s_add_u32 s56, s56, 8192
  s_add_u32 s49, s56, 96256
  s_add_u32 m0, s63, 8192
  s_nop 0
  buffer_load_dwordx4 v4, s[36:39], s56 offen offset:0 sc1 lds
  s_add_u32 m0, s63, 8960
  s_nop 0
  buffer_load_dwordx4 v4, s[36:39], s56 offen offset:256 sc1 lds
  s_add_u32 m0, s63, 10240
  s_nop 0
  buffer_load_dwordx4 v4, s[36:39], s49 offen offset:0 sc1 lds
  s_add_u32 m0, s63, 11008
  s_nop 0
  buffer_load_dwordx4 v4, s[36:39], s49 offen offset:256 sc1 lds
  s_add_u32 s56, s56, 8192
  s_waitcnt vmcnt(16)
  v_mfma_f32_16x16x32_bf16 v[8:11], v[140:143], v[124:127], v[8:11]
  v_mfma_f32_16x16x32_bf16 v[12:15], v[140:143], v[128:131], v[12:15]
  v_mfma_f32_16x16x32_bf16 v[16:19], v[140:143], v[132:135], v[16:19]
  v_mfma_f32_16x16x32_bf16 v[20:23], v[140:143], v[136:139], v[20:23]
  v_mfma_f32_16x16x32_bf16 v[24:27], v[144:147], v[124:127], v[24:27]
  v_mfma_f32_16x16x32_bf16 v[28:31], v[144:147], v[128:131], v[28:31]
  v_mfma_f32_16x16x32_bf16 v[32:35], v[144:147], v[132:135], v[32:35]
  v_mfma_f32_16x16x32_bf16 v[36:39], v[144:147], v[136:139], v[36:39]
  v_mfma_f32_16x16x32_bf16 v[40:43], v[148:151], v[124:127], v[40:43]
  v_mfma_f32_16x16x32_bf16 v[44:47], v[148:151], v[128:131], v[44:47]
  v_mfma_f32_16x16x32_bf16 v[48:51], v[148:151], v[132:135], v[48:51]
  v_mfma_f32_16x16x32_bf16 v[52:55], v[148:151], v[136:139], v[52:55]
  v_mfma_f32_16x16x32_bf16 v[56:59], v[152:155], v[124:127], v[56:59]
  v_mfma_f32_16x16x32_bf16 v[60:63], v[152:155], v[128:131], v[60:63]
  v_mfma_f32_16x16x32_bf16 v[64:67], v[152:155], v[132:135], v[64:67]
  v_mfma_f32_16x16x32_bf16 v[68:71], v[152:155], v[136:139], v[68:71]
  v_mfma_f32_16x16x32_bf16 v[72:75], v[156:159], v[124:127], v[72:75]
  v_mfma_f32_16x16x32_bf16 v[76:79], v[156:159], v[128:131], v[76:79]
  v_mfma_f32_16x16x32_bf16 v[80:83], v[156:159], v[132:135], v[80:83]
  v_mfma_f32_16x16x32_bf16 v[84:87], v[156:159], v[136:139], v[84:87]
  s_waitcnt vmcnt(8)
  ds_read_b128 v[124:127], v167 offset:0
  ds_read_b128 v[128:131], v167 offset:1024
  ds_read_b128 v[132:135], v167 offset:2048
  ds_read_b128 v[136:139], v167 offset:3072
  ds_read_b128 v[140:143], v166 offset:0
  ds_read_b128 v[144:147], v166 offset:1024
  ds_read_b128 v[148:151], v166 offset:2048
  ds_read_b128 v[152:155], v166 offset:3072
  ds_read_b128 v[156:159], v166 offset:4096
  s_waitcnt vmcnt(12)
  v_mfma_f32_16x16x32_bf16 v[8:11], v[104:107], v[88:91], v[8:11]
  v_mfma_f32_16x16x32_bf16 v[12:15], v[104:107], v[92:95], v[12:15]
  v_mfma_f32_16x16x32_bf16 v[16:19], v[104:107], v[96:99], v[16:19]
  v_mfma_f32_16x16x32_bf16 v[20:23], v[104:107], v[100:103], v[20:23]
  v_mfma_f32_16x16x32_bf16 v[24:27], v[108:111], v[88:91], v[24:27]
  v_mfma_f32_16x16x32_bf16 v[28:31], v[108:111], v[92:95], v[28:31]
  v_mfma_f32_16x16x32_bf16 v[32:35], v[108:111], v[96:99], v[32:35]
  v_mfma_f32_16x16x32_bf16 v[36:39], v[108:111], v[100:103], v[36:39]
  v_mfma_f32_16x16x32_bf16 v[40:43], v[112:115], v[88:91], v[40:43]
  v_mfma_f32_16x16x32_bf16 v[44:47], v[112:115], v[92:95], v[44:47]
  v_mfma_f32_16x16x32_bf16 v[48:51], v[112:115], v[96:99], v[48:51]
  v_mfma_f32_16x16x32_bf16 v[52:55], v[112:115], v[100:103], v[52:55]
  v_mfma_f32_16x16x32_bf16 v[56:59], v[116:119], v[88:91], v[56:59]
  v_mfma_f32_16x16x32_bf16 v[60:63], v[116:119], v[92:95], v[60:63]
  v_mfma_f32_16x16x32_bf16 v[64:67], v[116:119], v[96:99], v[64:67]
  v_mfma_f32_16x16x32_bf16 v[68:71], v[116:119], v[100:103], v[68:71]
  v_mfma_f32_16x16x32_bf16 v[72:75], v[120:123], v[88:91], v[72:75]
  v_mfma_f32_16x16x32_bf16 v[76:79], v[120:123], v[92:95], v[76:79]
  v_mfma_f32_16x16x32_bf16 v[80:83], v[120:123], v[96:99], v[80:83]
  v_mfma_f32_16x16x32_bf16 v[84:87], v[120:123], v[100:103], v[84:87]
  s_waitcnt lgkmcnt(4)
  s_waitcnt vmcnt(4)
  ds_read_b128 v[88:91], v167 offset:4096
  ds_read_b128 v[92:95], v167 offset:5120
  ds_read_b128 v[96:99], v167 offset:6144
  ds_read_b128 v[100:103], v167 offset:7168
  ds_read_b128 v[104:107], v166 offset:5120
  ds_read_b128 v[108:111], v166 offset:6144
  ds_read_b128 v[112:115], v166 offset:7168
  ds_read_b128 v[116:119], v166 offset:8192
  ds_read_b128 v[120:123], v166 offset:9216
  s_waitcnt lgkmcnt(9)
  v_mfma_f32_16x16x32_bf16 v[8:11], v[140:143], v[124:127], v[8:11]
  v_mfma_f32_16x16x32_bf16 v[12:15], v[140:143], v[128:131], v[12:15]
  v_mfma_f32_16x16x32_bf16 v[16:19], v[140:143], v[132:135], v[16:19]
  v_mfma_f32_16x16x32_bf16 v[20:23], v[140:143], v[136:139], v[20:23]
  v_mfma_f32_16x16x32_bf16 v[24:27], v[144:147], v[124:127], v[24:27]
  v_mfma_f32_16x16x32_bf16 v[28:31], v[144:147], v[128:131], v[28:31]
  v_mfma_f32_16x16x32_bf16 v[32:35], v[144:147], v[132:135], v[32:35]
  v_mfma_f32_16x16x32_bf16 v[36:39], v[144:147], v[136:139], v[36:39]
  v_mfma_f32_16x16x32_bf16 v[40:43], v[148:151], v[124:127], v[40:43]
  v_mfma_f32_16x16x32_bf16 v[44:47], v[148:151], v[128:131], v[44:47]
  v_mfma_f32_16x16x32_bf16 v[48:51], v[148:151], v[132:135], v[48:51]
  v_mfma_f32_16x16x32_bf16 v[52:55], v[148:151], v[136:139], v[52:55]
  v_mfma_f32_16x16x32_bf16 v[56:59], v[152:155], v[124:127], v[56:59]
  v_mfma_f32_16x16x32_bf16 v[60:63], v[152:155], v[128:131], v[60:63]
  v_mfma_f32_16x16x32_bf16 v[64:67], v[152:155], v[132:135], v[64:67]
  v_mfma_f32_16x16x32_bf16 v[68:71], v[152:155], v[136:139], v[68:71]
  v_mfma_f32_16x16x32_bf16 v[72:75], v[156:159], v[124:127], v[72:75]
  v_mfma_f32_16x16x32_bf16 v[76:79], v[156:159], v[128:131], v[76:79]
  v_mfma_f32_16x16x32_bf16 v[80:83], v[156:159], v[132:135], v[80:83]
  v_mfma_f32_16x16x32_bf16 v[84:87], v[156:159], v[136:139], v[84:87]
  s_waitcnt lgkmcnt(4)
  s_waitcnt vmcnt(0)
  ds_read_b128 v[124:127], v167 offset:8192
  ds_read_b128 v[128:131], v167 offset:9216
  ds_read_b128 v[132:135], v167 offset:10240
  ds_read_b128 v[136:139], v167 offset:11264
  ds_read_b128 v[140:143], v166 offset:10240
  ds_read_b128 v[144:147], v166 offset:11264
  ds_read_b128 v[148:151], v166 offset:12288
  ds_read_b128 v[152:155], v166 offset:13312
  ds_read_b128 v[156:159], v166 offset:14336
  s_waitcnt lgkmcnt(9)
  v_mfma_f32_16x16x32_bf16 v[8:11], v[104:107], v[88:91], v[8:11]
  v_mfma_f32_16x16x32_bf16 v[12:15], v[104:107], v[92:95], v[12:15]
  v_mfma_f32_16x16x32_bf16 v[16:19], v[104:107], v[96:99], v[16:19]
  v_mfma_f32_16x16x32_bf16 v[20:23], v[104:107], v[100:103], v[20:23]
  v_mfma_f32_16x16x32_bf16 v[24:27], v[108:111], v[88:91], v[24:27]
  v_mfma_f32_16x16x32_bf16 v[28:31], v[108:111], v[92:95], v[28:31]
  v_mfma_f32_16x16x32_bf16 v[32:35], v[108:111], v[96:99], v[32:35]
  v_mfma_f32_16x16x32_bf16 v[36:39], v[108:111], v[100:103], v[36:39]
  v_mfma_f32_16x16x32_bf16 v[40:43], v[112:115], v[88:91], v[40:43]
  v_mfma_f32_16x16x32_bf16 v[44:47], v[112:115], v[92:95], v[44:47]
  v_mfma_f32_16x16x32_bf16 v[48:51], v[112:115], v[96:99], v[48:51]
  v_mfma_f32_16x16x32_bf16 v[52:55], v[112:115], v[100:103], v[52:55]
  v_mfma_f32_16x16x32_bf16 v[56:59], v[116:119], v[88:91], v[56:59]
  v_mfma_f32_16x16x32_bf16 v[60:63], v[116:119], v[92:95], v[60:63]
  v_mfma_f32_16x16x32_bf16 v[64:67], v[116:119], v[96:99], v[64:67]
  v_mfma_f32_16x16x32_bf16 v[68:71], v[116:119], v[100:103], v[68:71]
  v_mfma_f32_16x16x32_bf16 v[72:75], v[120:123], v[88:91], v[72:75]
  v_mfma_f32_16x16x32_bf16 v[76:79], v[120:123], v[92:95], v[76:79]
  v_mfma_f32_16x16x32_bf16 v[80:83], v[120:123], v[96:99], v[80:83]
  v_mfma_f32_16x16x32_bf16 v[84:87], v[120:123], v[100:103], v[84:87]
  v_add_u32 v108, 0, v5
  v_mul_u32_u24 v109, 6554, v108
  v_lshrrev_b32 v109, 16, v109
  v_mul_u32_u24 v110, 10, v109
  v_sub_u32 v110, v108, v110
  v_mul_u32_u24 v111, 1280, v109
  v_lshl_add_u32 v100, v110, 4, v111
  v_mul_u32_u24 v111, 336, v109
  v_lshl_add_u32 v103, v110, 5, v111
  buffer_load_dwordx4 v[88:91], v100, s[24:27], s58 offen
  v_add_u32 v108, 256, v5
  v_mul_u32_u24 v109, 6554, v108
  v_lshrrev_b32 v109, 16, v109
  v_mul_u32_u24 v110, 10, v109
  v_sub_u32 v110, v108, v110
  v_mul_u32_u24 v111, 1280, v109
  v_lshl_add_u32 v101, v110, 4, v111
  v_mul_u32_u24 v111, 336, v109
  v_lshl_add_u32 v104, v110, 5, v111
  buffer_load_dwordx4 v[92:95], v101, s[24:27], s58 offen
  v_add_u32 v108, 512, v5
  v_mul_u32_u24 v109, 6554, v108
  v_lshrrev_b32 v109, 16, v109
  v_mul_u32_u24 v110, 10, v109
  v_sub_u32 v110, v108, v110
  v_mul_u32_u24 v111, 1280, v109
  v_lshl_add_u32 v102, v110, 4, v111
  v_mul_u32_u24 v111, 336, v109
  v_lshl_add_u32 v105, v110, 5, v111
  buffer_load_dwordx4 v[96:99], v102, s[24:27], s58 offen
  s_waitcnt lgkmcnt(0)
  v_mov_b32 v164, 66
  ds_write_b32 v7, v164
  v_and_b32 v108, 15, v1
  v_mul_u32_u24 v108, 336, v108
  v_lshrrev_b32 v109, 4, v1
  v_lshl_add_u32 v108, v109, 4, v108
  s_mul_i32 s48, s43, 21504
  v_add_u32 v4, s48, v108
  v_mfma_f32_16x16x32_bf16 v[8:11], v[140:143], v[124:127], v[8:11]
  v_mfma_f32_16x16x32_bf16 v[12:15], v[140:143], v[128:131], v[12:15]
  v_mfma_f32_16x16x32_bf16 v[16:19], v[140:143], v[132:135], v[16:19]
  v_mfma_f32_16x16x32_bf16 v[20:23], v[140:143], v[136:139], v[20:23]
  v_mfma_f32_16x16x32_bf16 v[24:27], v[144:147], v[124:127], v[24:27]
  v_mfma_f32_16x16x32_bf16 v[28:31], v[144:147], v[128:131], v[28:31]
  v_mfma_f32_16x16x32_bf16 v[32:35], v[144:147], v[132:135], v[32:35]
  v_mfma_f32_16x16x32_bf16 v[36:39], v[144:147], v[136:139], v[36:39]
LF_sp45:
  ds_read_b32 v164, v6
  s_waitcnt lgkmcnt(0)
  v_cmp_gt_u32 vcc, 66, v164
  s_nop 0
  s_cbranch_vccz LF_sp45d
  s_branch LF_sp45
LF_sp45d:
  v_mfma_f32_16x16x32_bf16 v[40:43], v[148:151], v[124:127], v[40:43]
  ds_write_b128 v4, v[8:11] offset:0
  v_mfma_f32_16x16x32_bf16 v[44:47], v[148:151], v[128:131], v[44:47]
  ds_write_b128 v4, v[12:15] offset:5376
  v_mfma_f32_16x16x32_bf16 v[48:51], v[148:151], v[132:135], v[48:51]
  ds_write_b128 v4, v[16:19] offset:10752
  v_mfma_f32_16x16x32_bf16 v[52:55], v[148:151], v[136:139], v[52:55]
  ds_write_b128 v4, v[20:23] offset:16128
  v_mfma_f32_16x16x32_bf16 v[56:59], v[152:155], v[124:127], v[56:59]
  ds_write_b128 v4, v[24:27] offset:64
  v_mfma_f32_16x16x32_bf16 v[60:63], v[152:155], v[128:131], v[60:63]
  ds_write_b128 v4, v[28:31] offset:5440
  v_mfma_f32_16x16x32_bf16 v[64:67], v[152:155], v[132:135], v[64:67]
  ds_write_b128 v4, v[32:35] offset:10816
  v_mfma_f32_16x16x32_bf16 v[68:71], v[152:155], v[136:139], v[68:71]
  ds_write_b128 v4, v[36:39] offset:16192
  v_mfma_f32_16x16x32_bf16 v[72:75], v[156:159], v[124:127], v[72:75]
  ds_write_b128 v4, v[40:43] offset:128
  v_mfma_f32_16x16x32_bf16 v[76:79], v[156:159], v[128:131], v[76:79]
  ds_write_b128 v4, v[44:47] offset:5504
  v_mfma_f32_16x16x32_bf16 v[80:83], v[156:159], v[132:135], v[80:83]
  ds_write_b128 v4, v[48:51] offset:10880
  v_mfma_f32_16x16x32_bf16 v[84:87], v[156:159], v[136:139], v[84:87]
  ds_write_b128 v4, v[52:55] offset:16256
  ds_write_b128 v4, v[56:59] offset:192
  ds_write_b128 v4, v[60:63] offset:5568
  ds_write_b128 v4, v[64:67] offset:10944
  ds_write_b128 v4, v[68:71] offset:16320
  ds_write_b128 v4, v[72:75] offset:256
  ds_write_b128 v4, v[76:79] offset:5632
  ds_write_b128 v4, v[80:83] offset:11008
  ds_write_b128 v4, v[84:87] offset:16384
  v_mov_b32 v164, 67
  s_waitcnt lgkmcnt(0)
  ds_write_b32 v7, v164
LF_sp46:
  ds_read_b32 v164, v6
  s_waitcnt lgkmcnt(0)
  v_cmp_gt_u32 vcc, 67, v164
  s_nop 0
  s_cbranch_vccz LF_sp46d
  s_branch LF_sp46
LF_sp46d:
  ds_read_b128 v[8:11], v103 offset:0
  ds_read_b128 v[12:15], v103 offset:16
  ds_read_b128 v[16:19], v103 offset:21504
  ds_read_b128 v[20:23], v103 offset:21520
  ds_read_b128 v[24:27], v103 offset:43008
  ds_read_b128 v[28:31], v103 offset:43024
  ds_read_b128 v[32:35], v103 offset:64512
  ds_read_b128 v[36:39], v103 offset:64528
  s_waitcnt lgkmcnt(4)
  ds_read_b128 v[40:43], v104 offset:0
  ds_read_b128 v[44:47], v104 offset:16
  ds_read_b128 v[48:51], v104 offset:21504
  ds_read_b128 v[52:55], v104 offset:21520
  ds_read_b128 v[56:59], v104 offset:43008
  ds_read_b128 v[60:63], v104 offset:43024
  ds_read_b128 v[64:67], v104 offset:64512
  ds_read_b128 v[68:71], v104 offset:64528
  s_waitcnt vmcnt(0)
  v_lshlrev_b32 v108, 16, v88
  v_and_b32 v109, 0xffff0000, v88
  v_lshlrev_b32 v110, 16, v89
  v_and_b32 v111, 0xffff0000, v89
  v_lshlrev_b32 v112, 16, v90
  v_and_b32 v113, 0xffff0000, v90
  v_lshlrev_b32 v114, 16, v91
  v_and_b32 v115, 0xffff0000, v91
  s_waitcnt lgkmcnt(8)
  v_pk_add_f32 v[8:9], v[8:9], v[16:17]
  v_pk_add_f32 v[24:25], v[24:25], v[32:33]
  v_pk_add_f32 v[10:11], v[10:11], v[18:19]
  v_pk_add_f32 v[26:27], v[26:27], v[34:35]
  v_pk_add_f32 v[12:13], v[12:13], v[20:21]
  v_pk_add_f32 v[28:29], v[28:29], v[36:37]
  v_pk_add_f32 v[14:15], v[14:15], v[22:23]
  v_pk_add_f32 v[30:31], v[30:31], v[38:39]
  v_pk_add_f32 v[8:9], v[8:9], v[108:109]
  v_pk_add_f32 v[10:11], v[10:11], v[110:111]
  v_pk_add_f32 v[12:13], v[12:13], v[112:113]
  v_pk_add_f32 v[14:15], v[14:15], v[114:115]
  v_pk_add_f32 v[8:9], v[8:9], v[24:25]
  v_pk_add_f32 v[10:11], v[10:11], v[26:27]
  v_pk_add_f32 v[12:13], v[12:13], v[28:29]
  v_pk_add_f32 v[14:15], v[14:15], v[30:31]
  v_cvt_pk_bf16_f32 v16, v8, v9
  v_cvt_pk_bf16_f32 v17, v10, v11
  v_cvt_pk_bf16_f32 v18, v12, v13
  v_cvt_pk_bf16_f32 v19, v14, v15
  buffer_store_dwordx4 v[16:19], v100, s[28:31], s58 offen sc1
  s_cmp_ge_u32 s43, 2
  s_cbranch_scc1 LF_two
  s_waitcnt lgkmcnt(4)
  ds_read_b128 v[124:127], v105 offset:0
  ds_read_b128 v[128:131], v105 offset:16
  ds_read_b128 v[132:135], v105 offset:21504
  ds_read_b128 v[136:139], v105 offset:21520
  ds_read_b128 v[140:143], v105 offset:43008
  ds_read_b128 v[144:147], v105 offset:43024
  ds_read_b128 v[148:151], v105 offset:64512
  ds_read_b128 v[152:155], v105 offset:64528
  v_lshlrev_b32 v108, 16, v96
  v_and_b32 v109, 0xffff0000, v96
  v_lshlrev_b32 v110, 16, v97
  v_and_b32 v111, 0xffff0000, v97
  v_lshlrev_b32 v112, 16, v98
  v_and_b32 v113, 0xffff0000, v98
  v_lshlrev_b32 v114, 16, v99
  v_and_b32 v115, 0xffff0000, v99
  s_waitcnt lgkmcnt(0)
  v_pk_add_f32 v[124:125], v[124:125], v[132:133]
  v_pk_add_f32 v[140:141], v[140:141], v[148:149]
  v_pk_add_f32 v[126:127], v[126:127], v[134:135]
  v_pk_add_f32 v[142:143], v[142:143], v[150:151]
  v_pk_add_f32 v[128:129], v[128:129], v[136:137]
  v_pk_add_f32 v[144:145], v[144:145], v[152:153]
  v_pk_add_f32 v[130:131], v[130:131], v[138:139]
  v_pk_add_f32 v[146:147], v[146:147], v[154:155]
  v_pk_add_f32 v[124:125], v[124:125], v[108:109]
  v_pk_add_f32 v[126:127], v[126:127], v[110:111]
  v_pk_add_f32 v[128:129], v[128:129], v[112:113]
  v_pk_add_f32 v[130:131], v[130:131], v[114:115]
  v_pk_add_f32 v[124:125], v[124:125], v[140:141]
  v_pk_add_f32 v[126:127], v[126:127], v[142:143]
  v_pk_add_f32 v[128:129], v[128:129], v[144:145]
  v_pk_add_f32 v[130:131], v[130:131], v[146:147]
  v_cvt_pk_bf16_f32 v132, v124, v125
  v_cvt_pk_bf16_f32 v133, v126, v127
  v_cvt_pk_bf16_f32 v134, v128, v129
  v_cvt_pk_bf16_f32 v135, v130, v131
  buffer_store_dwordx4 v[132:135], v102, s[28:31], s58 offen sc1
LF_two:
  v_lshlrev_b32 v108, 16, v92
  v_and_b32 v109, 0xffff0000, v92
  v_lshlrev_b32 v110, 16, v93
  v_and_b32 v111, 0xffff0000, v93
  v_lshlrev_b32 v112, 16, v94
  v_and_b32 v113, 0xffff0000, v94
  v_lshlrev_b32 v114, 16, v95
  v_and_b32 v115, 0xffff0000, v95
  s_waitcnt lgkmcnt(0)
  v_pk_add_f32 v[40:41], v[40:41], v[48:49]
  v_pk_add_f32 v[56:57], v[56:57], v[64:65]
  v_pk_add_f32 v[42:43], v[42:43], v[50:51]
  v_pk_add_f32 v[58:59], v[58:59], v[66:67]
  v_pk_add_f32 v[44:45], v[44:45], v[52:53]
  v_pk_add_f32 v[60:61], v[60:61], v[68:69]
  v_pk_add_f32 v[46:47], v[46:47], v[54:55]
  v_pk_add_f32 v[62:63], v[62:63], v[70:71]
  v_pk_add_f32 v[40:41], v[40:41], v[108:109]
  v_pk_add_f32 v[42:43], v[42:43], v[110:111]
  v_pk_add_f32 v[44:45], v[44:45], v[112:113]
  v_pk_add_f32 v[46:47], v[46:47], v[114:115]
  v_pk_add_f32 v[40:41], v[40:41], v[56:57]
  v_pk_add_f32 v[42:43], v[42:43], v[58:59]
  v_pk_add_f32 v[44:45], v[44:45], v[60:61]
  v_pk_add_f32 v[46:47], v[46:47], v[62:63]
  v_cvt_pk_bf16_f32 v48, v40, v41
  v_cvt_pk_bf16_f32 v49, v42, v43
  v_cvt_pk_bf16_f32 v50, v44, v45
  v_cvt_pk_bf16_f32 v51, v46, v47
  buffer_store_dwordx4 v[48:51], v101, s[28:31], s58 offen sc1
  s_branch LF_fin
LF_idle:
  v_mov_b32 v128, 0
  v_mov_b32 v129, 0
LF_sp47:
  ds_read_b32 v30, v31
  s_waitcnt lgkmcnt(0)
  v_cmp_gt_u32 vcc, 5, v30
  s_nop 0
  s_cbranch_vccz LF_sp47d
  s_sleep 8
  s_branch LF_sp47
LF_sp47d:
  v_mov_b32 v20, 32
  ds_write_b32 v7, v20
  s_mov_b32 s24, s4
  s_mov_b32 s25, s5
  s_mov_b32 s26, 819200
  s_mov_b32 s27, 0x20000
  s_mov_b32 s28, s6
  s_mov_b32 s29, s7
  s_mov_b32 s30, 1105920
  s_mov_b32 s31, 0x20000
  s_lshl1_add_u32 s56, s41, s42
  s_sub_u32 s56, s56, 14
  s_lshl2_add_u32 s56, s56, s43
  v_lshrrev_b32 v16, 3, v1
  v_mul_u32_u24 v16, 1280, v16
  v_and_b32 v17, 7, v1
  v_lshl_add_u32 v4, v17, 4, v16
  v_bfe_u32 v16, v1, 2, 2
  v_and_b32 v17, 3, v1
  v_lshlrev_b32 v17, 3, v17
  v_lshl_add_u32 v16, v16, 7, v17
  v_add_u32 v16, s58, v16
  v_lshrrev_b32 v17, 4, v1
  v_lshl_add_u32 v8, v17, 10, v16
  v_add_u32 v9, 512, v8
  v_lshrrev_b32 v18, 1, v17
  v_lshl_add_u32 v10, v18, 11, v16
  v_and_b32 v18, 1, v17
  v_lshl_add_u32 v10, v18, 9, v10
  v_add_u32 v11, 1024, v10
LF_iloop:
  s_mul_i32 s57, s56, 6554
  s_lshr_b32 s57, s57, 16
  s_mul_i32 s48, s57, 10
  s_sub_u32 s63, s56, s48
  s_lshl_b32 s49, s63, 7
  s_cmp_ge_u32 s57, 20
  s_cbranch_scc1 LF_idh
  s_mul_i32 s48, s57, 40960
  s_add_u32 s48, s48, s49
  s_add_u32 m0, s58, 0
  s_nop 0
  buffer_load_dwordx4 v4, s[24:27], s48 offen lds
  s_add_u32 s48, s48, 10240
  s_add_u32 m0, s58, 1024
  s_nop 0
  buffer_load_dwordx4 v4, s[24:27], s48 offen lds
  s_add_u32 s48, s48, 10240
  s_add_u32 m0, s58, 2048
  s_nop 0
  buffer_load_dwordx4 v4, s[24:27], s48 offen lds
  s_add_u32 s48, s48, 10240
  s_add_u32 m0, s58, 3072
  s_nop 0
  buffer_load_dwordx4 v4, s[24:27], s48 offen lds
  s_add_u32 s48, s48, 10240
  s_branch LF_itr
LF_idh:
  s_sub_u32 s48, s57, 20
  s_mul_i32 s48, s48, 40960
  s_add_u32 s48, s48, s49
  s_add_u32 m0, s58, 0
  s_nop 0
  buffer_load_dwordx4 v4, s[28:31], s48 offen lds
  s_add_u32 s48, s48, 10240
  s_add_u32 m0, s58, 1024
  s_nop 0
  buffer_load_dwordx4 v4, s[28:31], s48 offen lds
  s_add_u32 s48, s48, 10240
  s_add_u32 m0, s58, 2048
  s_nop 0
  buffer_load_dwordx4 v4, s[28:31], s48 offen lds
  s_add_u32 s48, s48, 10240
  s_add_u32 m0, s58, 3072
  s_nop 0
  buffer_load_dwordx4 v4, s[28:31], s48 offen lds
  s_add_u32 s48, s48, 10240
LF_itr:
  s_cmp_ge_u32 s57, 20
  s_cselect_b64 vcc, -1, 0
  v_cndmask_b32 v12, v8, v10, vcc
  v_cndmask_b32 v13, v9, v11, vcc
  s_waitcnt vmcnt(0)
  ds_read_b64_tr_b16 v[32:33], v12 offset:0
  ds_read_b64_tr_b16 v[34:35], v13 offset:0
  ds_read_b64_tr_b16 v[36:37], v12 offset:32
  ds_read_b64_tr_b16 v[38:39], v13 offset:32
  ds_read_b64_tr_b16 v[40:41], v12 offset:64
  ds_read_b64_tr_b16 v[42:43], v13 offset:64
  ds_read_b64_tr_b16 v[44:45], v12 offset:96
  ds_read_b64_tr_b16 v[46:47], v13 offset:96
  s_lshl2_add_u32 s48, s63, 0
  s_mul_i32 s49, s48, 13108
  s_lshr_b32 s49, s49, 16
  s_mul_i32 s50, s49, 230
  s_add_u32 s48, s48, s50
  s_mul_i32 s50, s57, 5
  s_add_u32 s48, s48, s50
  s_lshl_b32 s48, s48, 10
  s_add_u32 s48, s48, 16252928
  s_waitcnt lgkmcnt(6)
  buffer_store_dwordx4 v[32:35], v2, s[36:39], s48 offen sc0 sc1
  s_lshl2_add_u32 s48, s63, 1
  s_mul_i32 s49, s48, 13108
  s_lshr_b32 s49, s49, 16
  s_mul_i32 s50, s49, 230
  s_add_u32 s48, s48, s50
  s_mul_i32 s50, s57, 5
  s_add_u32 s48, s48, s50
  s_lshl_b32 s48, s48, 10
  s_add_u32 s48, s48, 16252928
  s_waitcnt lgkmcnt(4)
  buffer_store_dwordx4 v[36:39], v2, s[36:39], s48 offen sc0 sc1
  s_lshl2_add_u32 s48, s63, 2
  s_mul_i32 s49, s48, 13108
  s_lshr_b32 s49, s49, 16
  s_mul_i32 s50, s49, 230
  s_add_u32 s48, s48, s50
  s_mul_i32 s50, s57, 5
  s_add_u32 s48, s48, s50
  s_lshl_b32 s48, s48, 10
  s_add_u32 s48, s48, 16252928
  s_waitcnt lgkmcnt(2)
  buffer_store_dwordx4 v[40:43], v2, s[36:39], s48 offen sc0 sc1
  s_lshl2_add_u32 s48, s63, 3
  s_mul_i32 s49, s48, 13108
  s_lshr_b32 s49, s49, 16
  s_mul_i32 s50, s49, 230
  s_add_u32 s48, s48, s50
  s_mul_i32 s50, s57, 5
  s_add_u32 s48, s48, s50
  s_lshl_b32 s48, s48, 10
  s_add_u32 s48, s48, 16252928
  s_waitcnt lgkmcnt(0)
  buffer_store_dwordx4 v[44:47], v2, s[36:39], s48 offen sc0 sc1
  s_add_u32 s56, s56, 128
  s_cmp_lt_u32 s56, 470
  s_cbranch_scc1 LF_iloop
  s_and_b32 s56, s56, 127
  s_lshl3_add_u32 s49, s56, 19415040
  v_lshrrev_b32 v166, 0, v1
  v_lshlrev_b32 v166, 16, v166
  s_waitcnt vmcnt(0)
  s_mov_b32 exec_hi, 0
  s_mov_b32 exec_lo, 0x1
  buffer_store_dwordx2 v[160:161], v166, s[36:39], s49 offen sc0 sc1
  s_mov_b64 exec, -1
  s_branch LF_gend
LF_fin:
LF_end:
  s_endpgm
Lcode_end:
.section .rodata,"a"
.p2align 6
.amdhsa_kernel parallel_sum__grouped_kv_mqa__mixer_gmlp__prompt_kernel
  .amdhsa_next_free_vgpr 168
  .amdhsa_next_free_sgpr 64
  .amdhsa_accum_offset 168
  .amdhsa_group_segment_fixed_size 0
  .amdhsa_kernarg_size 104
  .amdhsa_user_sgpr_count 2
  .amdhsa_user_sgpr_kernarg_segment_ptr 1
  .amdhsa_system_sgpr_workgroup_id_x 1
.end_amdhsa_kernel
```
